```python
import torch

def _softmax(x, axis=-1):
    return torch.softmax(x, dim=axis)
def _gelu(x):
    return torch.nn.functional.gelu(x, approximate="tanh")
def _silu(x):
    return torch.nn.functional.silu(x)
def _sigmoid(x):
    return torch.sigmoid(x)
def _layernorm(x, axis=-1, eps=1e-5):
    m = x.mean(dim=axis, keepdim=True)
    v = x.var(dim=axis, keepdim=True, unbiased=False)
    return (x - m) / torch.sqrt(v + eps)
def _scatter_add(tgt, idx, src, axis=0):
    return tgt.clone().index_add_(axis, idx, src)
def _segment_sum(src, seg, n):
    out = torch.zeros((n,) + src.shape[1:], dtype=src.dtype)
    return out.index_add_(0, seg, src)
def _pad(x, pw):
    flat = tuple(v for pair in reversed(pw) for v in pair)
    return torch.nn.functional.pad(x, flat)

kernel_name = 'gated_mix__gqa_block_cached__gqa_block_cached__decode'

def setup_inputs():

    _w = (lambda a: (lambda t: t.to(torch.bfloat16) if t.is_floating_point() else t)(torch.as_tensor(a)))
    def _A_setup():
        B, Sq, D = 2, 1, 512
        Hq, Hkv, Sk, Dh = 32, 8, 32768, 128
        assert Hq % Hkv == 0, (Hq, Hkv)
        return {
            "x": _w((lambda *s: torch.randn(*s, dtype=torch.bfloat16) * 0.05)(B, Sq, D)),
            "k_cache": _w((lambda *s: torch.randn(*s, dtype=torch.bfloat16) * 6.4)(B, Hkv, Sk, Dh)),
            "v_cache": _w((lambda *s: torch.randn(*s, dtype=torch.bfloat16) * 0.05)(B, Hkv, Sk, Dh)),
            "wq": _w((lambda *s: torch.randn(*s, dtype=torch.bfloat16) * 6.4)(D, Hq * Dh) * (D ** -0.5)),
            "wo": _w((lambda *s: torch.randn(*s, dtype=torch.bfloat16) * 0.05)(Hq * Dh, D) * ((Hq * Dh) ** -0.5)),
        }
    _A_in = _A_setup()

    def _B_setup():
        B, Sq, D = 2, 1, 512
        Hq, Hkv, Sk, Dh = 32, 8, 32768, 128
        assert Hq % Hkv == 0, (Hq, Hkv)
        return {
            "x": _w((lambda *s: torch.randn(*s, dtype=torch.bfloat16) * 0.05)(B, Sq, D)),
            "k_cache": _w((lambda *s: torch.randn(*s, dtype=torch.bfloat16) * 6.4)(B, Hkv, Sk, Dh)),
            "v_cache": _w((lambda *s: torch.randn(*s, dtype=torch.bfloat16) * 0.05)(B, Hkv, Sk, Dh)),
            "wq": _w((lambda *s: torch.randn(*s, dtype=torch.bfloat16) * 6.4)(D, Hq * Dh) * (D ** -0.5)),
            "wo": _w((lambda *s: torch.randn(*s, dtype=torch.bfloat16) * 0.05)(Hq * Dh, D) * ((Hq * Dh) ** -0.5)),
        }
    _B_in = _B_setup()

    return {
        "A_x": _A_in["x"],
        "A_k_cache": _A_in["k_cache"],
        "A_v_cache": _A_in["v_cache"],
        "A_wq": _A_in["wq"],
        "A_wo": _A_in["wo"],
        "B_x": _B_in["x"],
        "B_k_cache": _B_in["k_cache"],
        "B_v_cache": _B_in["v_cache"],
        "B_wq": _B_in["wq"],
        "B_wo": _B_in["wo"],
        "gate_w": _w((lambda *s: torch.randn(*s, dtype=torch.bfloat16) * 0.1)(512) * 16.0),
    }

def reference(A_x, A_k_cache, A_v_cache, A_wq, A_wo, B_x, B_k_cache, B_v_cache, B_wq, B_wo, gate_w):
    def _A_ref(x, k_cache, v_cache, wq, wo):
        B, Sq, D = x.shape
        Hq, Dh = 32, 128
        Hkv = k_cache.shape[1]
        rep = Hq // Hkv
        q = (lambda x, *d: x.permute(*d))((x @ wq).reshape(B, Sq, Hq, Dh), 0, 2, 1, 3)
        k = (lambda x, n, axis: torch.repeat_interleave(x, n, dim=axis))(k_cache, rep, axis=1)
        v = (lambda x, n, axis: torch.repeat_interleave(x, n, dim=axis))(v_cache, rep, axis=1)
        scores = torch.einsum("bhqd,bhkd->bhqk", q, k) * (Dh ** -0.5)
        p = _softmax(scores, axis=-1)
        o = torch.einsum("bhqk,bhkd->bhqd", p, v)
        return (lambda x, *d: x.permute(*d))(o, 0, 2, 1, 3).reshape(B, Sq, Hq * Dh) @ wo

    def _B_ref(x, k_cache, v_cache, wq, wo):
        B, Sq, D = x.shape
        Hq, Dh = 32, 128
        Hkv = k_cache.shape[1]
        rep = Hq // Hkv
        q = (lambda x, *d: x.permute(*d))((x @ wq).reshape(B, Sq, Hq, Dh), 0, 2, 1, 3)
        k = (lambda x, n, axis: torch.repeat_interleave(x, n, dim=axis))(k_cache, rep, axis=1)
        v = (lambda x, n, axis: torch.repeat_interleave(x, n, dim=axis))(v_cache, rep, axis=1)
        scores = torch.einsum("bhqd,bhkd->bhqk", q, k) * (Dh ** -0.5)
        p = _softmax(scores, axis=-1)
        o = torch.einsum("bhqk,bhkd->bhqd", p, v)
        return (lambda x, *d: x.permute(*d))(o, 0, 2, 1, 3).reshape(B, Sq, Hq * Dh) @ wo

    x = A_x
    g = _sigmoid((x * gate_w).sum(-1, keepdims=True))
    a = _A_ref(x, A_k_cache, A_v_cache, A_wq, A_wo)
    b = _B_ref(x, B_k_cache, B_v_cache, B_wq, B_wo)
    return g * a + (1 - g) * b
```

```asm
; @launch grid=(256,1,1) block=(320,1,1) lds=57344
.amdgcn_target "amdgcn-amd-amdhsa--gfx950"
.text
.globl gated_mix__gqa_block_cached__gqa_block_cached__decode_kernel
.p2align 8
.type gated_mix__gqa_block_cached__gqa_block_cached__decode_kernel,@function
gated_mix__gqa_block_cached__gqa_block_cached__decode_kernel:
    s_cmp_ge_u32 s2, 256
    s_cbranch_scc1 L_end
    s_load_dwordx8 s[60:67], s[0:1], 8
    s_load_dwordx8 s[12:19], s[0:1], 64
    s_load_dwordx2 s[40:41], s[0:1], 0
    s_load_dwordx2 s[36:37], s[0:1], 104
    s_load_dwordx4 s[76:79], s[0:1], 48
    v_lshrrev_b32 v70, 6, v0
    v_and_b32 v0, 63, v0
    v_readfirstlane_b32 s3, v70
    v_cmp_gt_u32 vcc, 4, v70
    s_mov_b64 exec, vcc
L_pad0:
    s_cbranch_execz L_pad1
    v_lshrrev_b32 v71, 3, v0
    v_lshl_add_u32 v72, v70, 3, v71
    v_and_b32 v73, 7, v0
    v_lshlrev_b32 v73, 3, v73
    v_lshl_add_u32 v73, v72, 17, v73
    v_bfe_u32 v74, v0, 2, 1
    v_lshlrev_b32 v78, 10, v74
    v_lshl_add_u32 v78, v72, 5, v78
    s_movk_i32 s42, 0x800
    s_mov_b32 s43, 0x20000
    s_and_b32 s6, s2, 7
    s_lshr_b32 s7, s2, 3
    s_and_b32 s56, s7, 15
    s_lshl_b32 s56, s56, 6
    s_lshl_b32 s57, s6, 10
    s_add_u32 s56, s56, s57
    s_mov_b32 s30, 0x400000
    s_mov_b32 s31, 0x20000
    s_cmp_ge_u32 s2, 128
    s_waitcnt lgkmcnt(0)
    s_cselect_b64 s[28:29], s[12:13], s[64:65]
    buffer_load_dwordx4 v[196:199], v78, s[40:43], 0 offen
    buffer_load_dwordx4 v[200:203], v78, s[40:43], 0 offen offset:16
    buffer_load_dwordx2 v[212:213], v73, s[28:31], s56 offen nt
    s_addk_i32 s56, 0x2000
    buffer_load_dwordx2 v[214:215], v73, s[28:31], s56 offen nt
    s_addk_i32 s56, 0x2000
    s_load_dword s54, s[36:37], 0
    buffer_load_dwordx2 v[216:217], v73, s[28:31], s56 offen nt
    s_addk_i32 s56, 0x2000
    buffer_load_dwordx2 v[218:219], v73, s[28:31], s56 offen nt
    s_addk_i32 s56, 0x2000
    buffer_load_dwordx2 v[220:221], v73, s[28:31], s56 offen nt
    s_addk_i32 s56, 0x2000
    buffer_load_dwordx2 v[222:223], v73, s[28:31], s56 offen nt
    s_addk_i32 s56, 0x2000
    buffer_load_dwordx2 v[224:225], v73, s[28:31], s56 offen nt
    s_addk_i32 s56, 0x2000
    buffer_load_dwordx2 v[226:227], v73, s[28:31], s56 offen nt
    s_addk_i32 s56, 0x2000
    buffer_load_dwordx2 v[228:229], v73, s[28:31], s56 offen nt
    s_addk_i32 s56, 0x2000
    buffer_load_dwordx2 v[230:231], v73, s[28:31], s56 offen nt
    s_addk_i32 s56, 0x2000
    buffer_load_dwordx2 v[232:233], v73, s[28:31], s56 offen nt
    s_addk_i32 s56, 0x2000
    buffer_load_dwordx2 v[234:235], v73, s[28:31], s56 offen nt
    s_addk_i32 s56, 0x2000
    buffer_load_dwordx2 v[236:237], v73, s[28:31], s56 offen nt
    s_addk_i32 s56, 0x2000
    buffer_load_dwordx2 v[238:239], v73, s[28:31], s56 offen nt
    s_addk_i32 s56, 0x2000
    buffer_load_dwordx2 v[240:241], v73, s[28:31], s56 offen nt
    s_addk_i32 s56, 0x2000
    buffer_load_dwordx2 v[242:243], v73, s[28:31], s56 offen nt
    s_lshr_b32 s57, s2, 7
    s_lshl_b32 s57, s57, 3
    s_add_u32 s57, s57, s6
    s_lshl_b32 s57, s57, 23
    s_mov_b32 s22, 0x800000
    s_mov_b32 s23, 0x20000
    s_and_b32 s73, s3, 1
    s_lshl_b32 s73, s73, 12
    s_and_b32 s53, s3, 2
    s_lshl_b32 s53, s53, 17
    s_add_u32 s73, s73, s53
    s_and_b32 s53, s7, 1
    s_lshl_b32 s53, s53, 9
    s_add_u32 s73, s73, s53
    s_and_b32 s53, s7, 2
    s_lshl_b32 s53, s53, 10
    s_add_u32 s73, s73, s53
    s_and_b32 s53, s7, 4
    s_lshl_b32 s53, s53, 13
    s_add_u32 s73, s73, s53
    s_and_b32 s53, s7, 8
    s_lshl_b32 s53, s53, 11
    s_add_u32 s73, s73, s53
    v_bfe_u32 v75, v0, 2, 2
    v_lshrrev_b32 v76, 4, v0
    v_and_b32 v77, 3, v0
    v_lshlrev_b32 v3, 4, v0
    v_lshl_add_u32 v1, v76, 6, s73
    v_lshl_add_u32 v1, v77, 4, v1
    v_lshl_add_u32 v1, v74, 13, v1
    v_bfe_u32 v79, v0, 3, 1
    v_lshl_add_u32 v1, v79, 16, v1
    s_mov_b32 s28, s14
    s_mov_b32 s29, s15
    s_add_u32 s20, s60, s57
    s_addc_u32 s21, s61, 0
    buffer_load_dwordx4 v[84:87], v1, s[20:23], 0 offen nt
    buffer_load_dwordx4 v[88:91], v1, s[20:23], 0 offen offset:256 nt
    buffer_load_dwordx4 v[92:95], v1, s[20:23], 0 offen offset:1024 nt
    v_and_b32 v2, 0xff, v3
    v_add_u32 v2, s73, v2
L_pad1:
    s_cbranch_execz L_pad2
    v_bfe_u32 v78, v0, 4, 1
    v_lshl_add_u32 v2, v78, 13, v2
    v_lshrrev_b32 v78, 5, v0
    v_lshl_add_u32 v2, v78, 16, v2
    s_add_u32 s24, s62, s57
    s_addc_u32 s25, s63, 0
    s_add_u32 s76, s76, s57
    s_addc_u32 s77, s77, 0
    s_add_u32 s78, s78, s57
    s_addc_u32 s79, s79, 0
    s_mov_b32 s26, 0x800000
    s_mov_b32 s27, 0x20000
    s_mov_b32 s38, 0x400000
    s_mov_b32 s39, 0x20000
    s_mov_b32 s32, s66
    s_mov_b32 s33, s67
    s_mov_b32 s34, 0x400000
    s_mov_b32 s35, 0x20000
    s_mov_b32 s44, s16
    s_mov_b32 s45, s17
    s_mov_b32 s46, 0x400
    s_mov_b32 s47, 0x20000
    s_mov_b32 s48, s18
    s_mov_b32 s49, s19
    s_mov_b32 s50, 0x800
    s_mov_b32 s51, 0x20000
    s_mov_b32 s55, 0x3fb8aa3b
    s_mov_b32 s59, 0
    s_mov_b32 s60, 0x22222222
    s_mov_b32 s61, 0x22222222
    s_mov_b32 s62, 0x44444444
    s_mov_b32 s63, 0x44444444
    s_mov_b32 s64, 0x88888888
    s_mov_b32 s65, 0x88888888
    v_mov_b32 v78, 0xffff
    v_mov_b32 v79, 0xffff0000
    v_cndmask_b32 v5, 0, v78, s[62:63]
    v_cndmask_b32 v5, v5, v79, s[64:65]
    v_cndmask_b32 v4, v78, v79, s[60:61]
    v_cmp_gt_u32 vcc, 2, v77
    s_nop 1
    v_cndmask_b32 v4, 0, v4, vcc
    s_mov_b32 s56, 0x01000100
    s_mov_b32 s57, 0x03020302
    v_mov_b32 v78, 0x0c0c0c0c
    v_bfi_b32 v204, v4, s56, v78
    v_bfi_b32 v205, v5, s56, v78
    v_bfi_b32 v206, v4, s57, v78
    v_bfi_b32 v207, v5, s57, v78
    v_mov_b32 v52, 0
    v_mov_b32 v53, 0
    v_mov_b32 v56, 0
    v_mov_b32 v57, 0
    v_mov_b32 v60, 0
    v_mov_b32 v61, 0
    v_mov_b32 v64, 0
    v_mov_b32 v65, 0
    v_mov_b32 v68, 0
    v_mov_b32 v69, 0
    v_mov_b32 v10, 0xff800000
    v_mov_b32 v11, 0
    v_mov_b32 v15, 0x7ffffff0
    v_lshlrev_b32 v12, 3, v0
    v_lshl_add_u32 v12, v70, 13, v12
    v_lshl_add_u32 v78, v70, 10, v3
    s_getreg_b32 s8, hwreg(HW_REG_XCC_ID)
    s_and_b32 s8, s8, 7
    s_waitcnt vmcnt(17)
    v_perm_b32 v208, v196, v196, v204
    v_perm_b32 v209, v196, v196, v205
    v_perm_b32 v210, v196, v196, v206
    v_perm_b32 v211, v196, v196, v207
    s_nop 1
    v_mfma_f32_16x16x32_bf16 v[44:47], v[212:215], v[208:211], 0
    s_waitcnt vmcnt(15)
    v_perm_b32 v208, v197, v197, v204
    v_perm_b32 v209, v197, v197, v205
    v_perm_b32 v210, v197, v197, v206
    v_perm_b32 v211, v197, v197, v207
    s_nop 1
    v_mfma_f32_16x16x32_bf16 v[44:47], v[216:219], v[208:211], v[44:47]
    s_waitcnt vmcnt(13)
    v_perm_b32 v208, v198, v198, v204
    v_perm_b32 v209, v198, v198, v205
    v_perm_b32 v210, v198, v198, v206
    v_perm_b32 v211, v198, v198, v207
    s_nop 1
    v_mfma_f32_16x16x32_bf16 v[44:47], v[220:223], v[208:211], v[44:47]
    s_waitcnt vmcnt(11)
    v_perm_b32 v208, v199, v199, v204
    v_perm_b32 v209, v199, v199, v205
    v_perm_b32 v210, v199, v199, v206
    v_perm_b32 v211, v199, v199, v207
    s_nop 1
    v_mfma_f32_16x16x32_bf16 v[44:47], v[224:227], v[208:211], v[44:47]
    s_waitcnt vmcnt(9)
L_pad2:
    s_cbranch_execz L_pad3
    v_perm_b32 v208, v200, v200, v204
    v_perm_b32 v209, v200, v200, v205
    v_perm_b32 v210, v200, v200, v206
    v_perm_b32 v211, v200, v200, v207
    s_nop 1
    v_mfma_f32_16x16x32_bf16 v[44:47], v[228:231], v[208:211], v[44:47]
    s_waitcnt vmcnt(7)
    v_perm_b32 v208, v201, v201, v204
    v_perm_b32 v209, v201, v201, v205
    v_perm_b32 v210, v201, v201, v206
    v_perm_b32 v211, v201, v201, v207
    s_nop 1
    v_mfma_f32_16x16x32_bf16 v[44:47], v[232:235], v[208:211], v[44:47]
    s_waitcnt vmcnt(5)
    buffer_load_dwordx4 v[96:99], v1, s[20:23], 0 offen offset:1280 nt
    v_perm_b32 v208, v202, v202, v204
    v_perm_b32 v209, v202, v202, v205
    v_perm_b32 v210, v202, v202, v206
    v_perm_b32 v211, v202, v202, v207
    s_nop 1
    v_mfma_f32_16x16x32_bf16 v[44:47], v[236:239], v[208:211], v[44:47]
    s_waitcnt vmcnt(4)
    s_mov_b32 s52, 0x400000
    buffer_load_dwordx4 v[100:103], v1, s[20:23], s52 offen nt
    v_perm_b32 v208, v203, v203, v204
    v_perm_b32 v209, v203, v203, v205
    v_perm_b32 v210, v203, v203, v206
    v_perm_b32 v211, v203, v203, v207
    s_nop 1
    v_mfma_f32_16x16x32_bf16 v[44:47], v[240:243], v[208:211], v[44:47]
    buffer_load_dwordx4 v[104:107], v1, s[20:23], s52 offen offset:256 nt
    buffer_load_dwordx4 v[108:111], v1, s[20:23], s52 offen offset:1024 nt
    s_nop 5
    ds_write_b128 v78, v[44:47] offset:53248
    v_bfe_u32 v79, v0, 4, 1
    v_lshlrev_b32 v79, 8, v79
    v_lshrrev_b32 v80, 5, v0
    v_lshl_add_u32 v79, v80, 6, v79
    v_lshl_add_u32 v79, v77, 4, v79
    v_lshl_add_u32 v79, v75, 2, v79
    s_waitcnt lgkmcnt(0)
    s_barrier
    s_add_u32 s54, s54, 1
    s_cmp_lg_u32 s3, 0
    s_cbranch_scc1 L_nopub
    ds_read_b32 v212, v79 offset:53248
    ds_read_b32 v213, v79 offset:53888
    ds_read_b32 v214, v79 offset:54272
    ds_read_b32 v215, v79 offset:54912
    ds_read_b32 v216, v79 offset:55296
    ds_read_b32 v217, v79 offset:55936
    ds_read_b32 v218, v79 offset:56320
    ds_read_b32 v219, v79 offset:56960
    s_lshr_b32 s56, s2, 7
    s_lshl_b32 s56, s56, 3
    s_add_u32 s56, s56, s6
    s_lshl_b32 s56, s56, 12
    s_and_b32 s57, s7, 15
    s_lshl_b32 s57, s57, 7
    s_add_u32 s56, s56, s57
    s_add_u32 s56, s56, 0x10000
    v_and_b32 v81, 31, v0
    v_lshlrev_b32 v81, 2, v81
    v_lshl_add_u32 v81, v80, 11, v81
    v_mad_u32_u24 v80, v77, 6, 7
    v_cmp_ne_u32 vcc, 0, v77
    v_lshrrev_b32_e64 v80, v80, s54
    v_mad_u32_u24 v78, v77, 37, s54
    v_cndmask_b32 v80, 0, v80, vcc
    v_add_u32 v80, v78, v80
    v_and_b32 v80, 0x1fff, v80
    v_lshl_or_b32 v80, s8, 13, v80
    s_waitcnt lgkmcnt(0)
    v_add_f32 v212, v212, v216
    v_add_f32 v213, v213, v217
    v_add_f32 v214, v214, v218
    v_add_f32 v215, v215, v219
    v_add_f32 v212, v212, v214
    v_add_f32 v213, v213, v215
    v_add_f32 v212, v212, v213
    v_cvt_pk_bf16_f32 v212, 0, v212
    v_or_b32 v14, v80, v212
    v_add_u32 v15, s56, v81
    buffer_store_dword v14, v15, s[36:39], 0 offen
L_nopub:
    s_waitcnt vmcnt(4)
    buffer_load_dwordx4 v[112:115], v1, s[20:23], s52 offen offset:1280 nt
    s_lshl_b32 s5, s8, 13
    s_add_u32 s68, s54, 0
    s_and_b32 s96, s68, 0x1fff
    s_or_b32 s96, s96, s5
    s_and_b32 s68, s68, 0xff
    s_add_u32 s69, s54, 37
    s_waitcnt vmcnt(4)
    s_mov_b32 s52, 0x200000
    buffer_load_dwordx4 v[116:119], v1, s[20:23], s52 offen nt
    s_lshr_b32 s4, s54, 13
L_pad3:
    s_cbranch_execz L_hbar
    s_add_u32 s97, s69, s4
    s_lshr_b32 s4, s54, 8
    s_add_u32 s69, s69, s4
    s_and_b32 s97, s97, 0x1fff
    s_or_b32 s97, s97, s5
    s_waitcnt vmcnt(4)
    buffer_load_dwordx4 v[120:123], v1, s[20:23], s52 offen offset:256 nt
    s_and_b32 s69, s69, 0xff
    s_add_u32 s70, s54, 74
    s_lshr_b32 s4, s54, 19
    s_add_u32 s98, s70, s4
    s_lshr_b32 s4, s54, 16
    s_add_u32 s70, s70, s4
    s_waitcnt vmcnt(4)
    buffer_load_dwordx4 v[124:127], v1, s[20:23], s52 offen offset:1024 nt
    s_and_b32 s98, s98, 0x1fff
    s_or_b32 s98, s98, s5
    s_and_b32 s70, s70, 0xff
    s_add_u32 s71, s54, 111
    s_lshr_b32 s4, s54, 25
    s_add_u32 s99, s71, s4
    s_waitcnt vmcnt(4)
    buffer_load_dwordx4 v[128:131], v1, s[20:23], s52 offen offset:1280 nt
    s_lshr_b32 s4, s54, 24
    s_add_u32 s71, s71, s4
    s_and_b32 s99, s99, 0x1fff
    s_or_b32 s99, s99, s5
    s_and_b32 s71, s71, 0xff
    v_lshl_add_u32 v79, v75, 2, v76
    s_waitcnt vmcnt(4)
    s_mov_b32 s52, 0x600000
    buffer_load_dwordx4 v[132:135], v1, s[20:23], s52 offen nt
    v_lshlrev_b32 v79, 7, v79
    v_lshl_add_u32 v79, v77, 5, v79
    s_lshl_b32 s56, s6, 1
    s_lshr_b32 s57, s2, 7
    s_add_u32 s56, s56, s57
    s_lshl_b32 s56, s56, 11
    s_waitcnt vmcnt(4)
    buffer_load_dwordx4 v[136:139], v1, s[20:23], s52 offen offset:256 nt
    s_add_u32 s56, s56, 0x10000
    s_add_u32 s57, s56, 32768
    s_mov_b32 s58, 4194304
    s_lshl_b32 s9, s3, 21
    s_load_dword s10, s[24:25], s9
    s_load_dword s11, s[76:77], s9
    s_waitcnt vmcnt(4)
    buffer_load_dwordx4 v[140:143], v1, s[20:23], s52 offen offset:1024 nt
    s_load_dword s12, s[78:79], s9
    s_lshl_b32 s13, s6, 19
    s_load_dword s14, s[32:33], s13
    s_load_dword s15, s[28:29], s13
    s_load_dword s16, s[20:21], s9
    s_getpc_b64 s[18:19]
L_pc:
    s_waitcnt vmcnt(4)
    buffer_load_dwordx4 v[144:147], v1, s[20:23], s52 offen offset:1280 nt
    s_sub_u32 s18, s18, L_pc-gated_mix__gqa_block_cached__gqa_block_cached__decode_kernel
    s_subb_u32 s19, s19, 0
    s_lshl_b32 s17, s7, 2
    s_add_u32 s17, s17, s3
    s_lshl_b32 s17, s17, 7
    s_min_u32 s17, s17, L_last-gated_mix__gqa_block_cached__gqa_block_cached__decode_kernel
    s_load_dword s17, s[18:19], s17
    s_waitcnt vmcnt(4)
    s_mov_b32 s52, 0x80000
    buffer_load_dwordx4 v[148:151], v1, s[20:23], s52 offen nt
    s_lshl_b32 s4, s8, 2
    s_lshr_b32 s4, 0xd8d8d8d8, s4
    s_and_b32 s4, s4, 15
    s_add_u32 s75, s4, 20
    s_lshl_b32 s4, s8, 12
    s_add_u32 s4, s4, 0x40000
    s_waitcnt vmcnt(4)
    buffer_load_dwordx4 v[152:155], v1, s[20:23], s52 offen offset:256 nt
    v_lshl_add_u32 v23, v0, 2, s4
    v_mov_b32 v25, 0x7ffffff0
    s_lshl_b32 s5, s3, 6
    s_add_u32 s5, s5, s7
    v_cmp_eq_u32 vcc, s5, v0
    s_lshl_b32 s74, s54, 12
    s_waitcnt vmcnt(4)
    buffer_load_dwordx4 v[156:159], v1, s[20:23], s52 offen offset:1024 nt
    s_mov_b32 s66, 0
    v_cndmask_b32 v22, v25, v23, vcc
    v_add_u32 v25, s74, v25
    s_mov_b32 s4, 0x5238a182
    s_mov_b32 s5, 0x9217595
    s_mul_i32 s72, s7, 6
    s_waitcnt vmcnt(4)
    buffer_load_dwordx4 v[160:163], v1, s[20:23], s52 offen offset:1280 nt
    s_lshr_b64 s[4:5], s[4:5], s72
    s_sub_u32 s72, s72, 60
    s_lshr_b32 s5, 0x30b28, s72
    s_cmp_lt_u32 s7, 10
    s_cselect_b32 s4, s4, s5
    s_and_b32 s4, s4, 63
L_pad4:
    s_cbranch_execz L_pad5
    s_xor_b32 s5, s3, 3
    s_waitcnt vmcnt(4)
    s_mov_b32 s52, 0x480000
    buffer_load_dwordx4 v[164:167], v1, s[20:23], s52 offen nt
    s_lshl_b32 s5, s5, 5
    s_add_u32 s5, s5, s7
    s_cmp_lt_u32 s5, 13
    s_cselect_b32 s4, s4, 0x400
    s_add_u32 s72, s74, s4
    s_lshl_b32 s4, s6, 11
    s_lshr_b32 s5, s2, 7
    s_waitcnt vmcnt(4)
    buffer_load_dwordx4 v[168:171], v1, s[20:23], s52 offen offset:256 nt
    s_lshl_b32 s5, s5, 10
    s_add_u32 s4, s4, s5
    s_add_u32 s4, s4, 0x30000
    v_add_u32 v26, s4, v3
    v_mov_b32 v27, 0xffffff00
    s_waitcnt vmcnt(4)
    buffer_load_dwordx4 v[172:175], v1, s[20:23], s52 offen offset:1024 nt
    s_waitcnt vmcnt(4)
    buffer_load_dwordx4 v[176:179], v1, s[20:23], s52 offen offset:1280 nt
    s_waitcnt vmcnt(4)
    s_mov_b32 s52, 0x280000
    buffer_load_dwordx4 v[180:183], v1, s[20:23], s52 offen nt
    s_waitcnt vmcnt(4)
    buffer_load_dwordx4 v[184:187], v1, s[20:23], s52 offen offset:256 nt
    s_waitcnt vmcnt(4)
    buffer_load_dwordx4 v[188:191], v1, s[20:23], s52 offen offset:1024 nt
    s_waitcnt vmcnt(4)
    buffer_load_dwordx4 v[192:195], v1, s[20:23], s52 offen offset:1280 nt
    s_waitcnt vmcnt(4)
    s_mov_b32 s52, 0x680000
    buffer_load_dwordx4 v[196:199], v1, s[20:23], s52 offen nt
    s_waitcnt vmcnt(4)
    buffer_load_dwordx4 v[200:203], v1, s[20:23], s52 offen offset:256 nt
    s_waitcnt vmcnt(4)
    buffer_load_dwordx4 v[204:207], v1, s[20:23], s52 offen offset:1024 nt
    s_waitcnt vmcnt(4)
    buffer_load_dwordx4 v[208:211], v1, s[20:23], s52 offen offset:1280 nt
    s_waitcnt vmcnt(4)
    s_mov_b32 s52, 0x100000
    buffer_load_dwordx4 v[212:215], v1, s[20:23], s52 offen nt
    s_waitcnt vmcnt(4)
    buffer_load_dwordx4 v[216:219], v1, s[20:23], s52 offen offset:256 nt
    s_waitcnt vmcnt(4)
    buffer_load_dwordx4 v[36:39], v79, s[36:39], s56 offen nt
    buffer_load_dwordx4 v[40:43], v79, s[36:39], s56 offen offset:16 nt
    buffer_load_dwordx4 v[44:47], v79, s[36:39], s57 offen nt
    buffer_load_dwordx4 v[48:51], v79, s[36:39], s57 offen offset:16 nt
    buffer_load_dwordx4 v[220:223], v1, s[20:23], s52 offen offset:1024 nt
    s_waitcnt vmcnt(8)
    buffer_load_dwordx4 v[224:227], v1, s[20:23], s52 offen offset:1280 nt
    s_waitcnt vmcnt(8)
    s_mov_b32 s52, 0x500000
    buffer_load_dwordx4 v[228:231], v1, s[20:23], s52 offen nt
    s_waitcnt vmcnt(8)
    buffer_load_dwordx4 v[232:235], v1, s[20:23], s52 offen offset:256 nt
    s_waitcnt vmcnt(8)
    buffer_load_dwordx4 v[236:239], v1, s[20:23], s52 offen offset:1024 nt
    s_waitcnt vmcnt(4)
    buffer_load_dwordx4 v[240:243], v1, s[20:23], s52 offen offset:1280 nt
    s_waitcnt vmcnt(6)
    v_xor_b32 v78, s96, v36
    v_bitop3_b32 v78, v37, s97, v78 bitop3:0xbe
    v_bitop3_b32 v78, v38, s98, v78 bitop3:0xbe
    v_bitop3_b32 v78, v39, s99, v78 bitop3:0xbe
    v_bitop3_b32 v78, v40, s96, v78 bitop3:0xbe
    v_bitop3_b32 v78, v41, s97, v78 bitop3:0xbe
    v_bitop3_b32 v78, v42, s98, v78 bitop3:0xbe
    v_bitop3_b32 v78, v43, s99, v78 bitop3:0xbe
    v_bitop3_b32 v78, v44, s96, v78 bitop3:0xbe
    v_bitop3_b32 v78, v45, s97, v78 bitop3:0xbe
    v_bitop3_b32 v78, v46, s98, v78 bitop3:0xbe
    v_bitop3_b32 v78, v47, s99, v78 bitop3:0xbe
    v_bitop3_b32 v78, v48, s96, v78 bitop3:0xbe
    v_bitop3_b32 v78, v49, s97, v78 bitop3:0xbe
    v_bitop3_b32 v78, v50, s98, v78 bitop3:0xbe
    v_bitop3_b32 v78, v51, s99, v78 bitop3:0xbe
    v_and_b32 v80, 0xffff, v78
    v_cmp_ne_u32 vcc, 0, v80
    s_cbranch_vccnz L_qslow
L_qok:
    s_mov_b32 s4, 0x07060302
    v_perm_b32 v28, v37, v36, s4
    v_perm_b32 v29, v39, v38, s4
    v_perm_b32 v30, v41, v40, s4
    v_perm_b32 v31, v43, v42, s4
    v_perm_b32 v32, v45, v44, s4
    v_perm_b32 v33, v47, v46, s4
    v_perm_b32 v34, v49, v48, s4
    v_perm_b32 v35, v51, v50, s4
    s_cmp_eq_u64 vcc, 0
    s_cselect_b32 s67, 1, 0
    v_mfma_f32_16x16x32_bf16 v[44:47], v[84:87], v[28:31], 0
    s_waitcnt vmcnt(5)
    s_mov_b32 s52, 0x300000
L_pad5:
    s_cbranch_execz L_pad6
    buffer_load_dwordx4 v[84:87], v1, s[20:23], s52 offen nt
    v_mfma_f32_16x16x32_bf16 v[48:51], v[88:91], v[28:31], 0
    s_nop 3
    v_add_f32_dpp v17, v45, v44 quad_perm:[1,0,3,2] row_mask:0xf bank_mask:0xf
    v_add_f32_dpp v18, v47, v46 quad_perm:[1,0,3,2] row_mask:0xf bank_mask:0xf
    s_nop 1
    v_add_f32_dpp v6, v18, v17 quad_perm:[2,3,0,1] row_mask:0xf bank_mask:0xf
    v_mfma_f32_16x16x32_bf16 v[44:47], v[92:95], v[28:31], 0
    v_add_f32_dpp v17, v48, v49 quad_perm:[1,0,3,2] row_mask:0xf bank_mask:0xf
    v_add_f32_dpp v18, v50, v51 quad_perm:[1,0,3,2] row_mask:0xf bank_mask:0xf
    s_nop 1
    v_add_f32_dpp v19, v18, v17 quad_perm:[2,3,0,1] row_mask:0xf bank_mask:0xf
    v_cndmask_b32 v6, v6, v19, s[60:61]
    v_mfma_f32_16x16x32_bf16 v[48:51], v[96:99], v[28:31], 0
    s_nop 0
    v_add_f32_dpp v17, v47, v46 quad_perm:[1,0,3,2] row_mask:0xf bank_mask:0xf
    v_add_f32_dpp v18, v45, v44 quad_perm:[1,0,3,2] row_mask:0xf bank_mask:0xf
    s_nop 1
    v_add_f32_dpp v19, v18, v17 quad_perm:[2,3,0,1] row_mask:0xf bank_mask:0xf
    v_cndmask_b32 v6, v6, v19, s[62:63]
    s_waitcnt vmcnt(5)
    buffer_load_dwordx4 v[88:91], v1, s[20:23], s52 offen offset:256 nt
    v_mfma_f32_16x16x32_bf16 v[44:47], v[100:103], v[28:31], 0
    v_add_f32_dpp v17, v50, v51 quad_perm:[1,0,3,2] row_mask:0xf bank_mask:0xf
    v_add_f32_dpp v18, v48, v49 quad_perm:[1,0,3,2] row_mask:0xf bank_mask:0xf
    s_nop 1
    v_add_f32_dpp v19, v18, v17 quad_perm:[2,3,0,1] row_mask:0xf bank_mask:0xf
    v_cndmask_b32 v6, v6, v19, s[64:65]
    v_cvt_pk_bf16_f32 v6, 0, v6
    v_mul_f32 v6, 0x3db504f3, v6
    v_cvt_pk_bf16_f32 v6, 0, v6
    v_mfma_f32_16x16x32_bf16 v[48:51], v[104:107], v[28:31], 0
    v_add_f32_dpp v17, v45, v44 quad_perm:[1,0,3,2] row_mask:0xf bank_mask:0xf
    v_add_f32_dpp v18, v47, v46 quad_perm:[1,0,3,2] row_mask:0xf bank_mask:0xf
    s_nop 1
    v_add_f32_dpp v7, v18, v17 quad_perm:[2,3,0,1] row_mask:0xf bank_mask:0xf
    v_mfma_f32_16x16x32_bf16 v[44:47], v[108:111], v[28:31], 0
    s_nop 1
    v_add_f32_dpp v17, v48, v49 quad_perm:[1,0,3,2] row_mask:0xf bank_mask:0xf
    v_add_f32_dpp v18, v50, v51 quad_perm:[1,0,3,2] row_mask:0xf bank_mask:0xf
    s_nop 1
    v_add_f32_dpp v19, v18, v17 quad_perm:[2,3,0,1] row_mask:0xf bank_mask:0xf
    v_cndmask_b32 v7, v7, v19, s[60:61]
    s_waitcnt vmcnt(5)
    buffer_load_dwordx4 v[92:95], v1, s[20:23], s52 offen offset:1024 nt
    v_mfma_f32_16x16x32_bf16 v[48:51], v[112:115], v[28:31], 0
    v_add_f32_dpp v17, v47, v46 quad_perm:[1,0,3,2] row_mask:0xf bank_mask:0xf
    v_add_f32_dpp v18, v45, v44 quad_perm:[1,0,3,2] row_mask:0xf bank_mask:0xf
    s_nop 1
    v_add_f32_dpp v19, v18, v17 quad_perm:[2,3,0,1] row_mask:0xf bank_mask:0xf
    v_cndmask_b32 v7, v7, v19, s[62:63]
    v_mfma_f32_16x16x32_bf16 v[44:47], v[116:119], v[28:31], 0
    s_nop 0
    v_add_f32_dpp v17, v50, v51 quad_perm:[1,0,3,2] row_mask:0xf bank_mask:0xf
    v_add_f32_dpp v18, v48, v49 quad_perm:[1,0,3,2] row_mask:0xf bank_mask:0xf
    s_nop 1
    v_add_f32_dpp v19, v18, v17 quad_perm:[2,3,0,1] row_mask:0xf bank_mask:0xf
    v_cndmask_b32 v7, v7, v19, s[64:65]
    v_cvt_pk_bf16_f32 v7, 0, v7
    v_mul_f32 v7, 0x3db504f3, v7
    v_cvt_pk_bf16_f32 v7, 0, v7
    v_mul_f32 v16, s55, v10
    v_max3_f32 v10, v6, v7, v10
    ds_write_b64 v12, v[6:7]
    v_mul_f32 v20, s55, v10
    v_add_u32 v12, 512, v12
    v_fma_f32 v14, v6, s55, -v20
    v_fma_f32 v15, v7, s55, -v20
    v_sub_f32 v16, v16, v20
    v_mfma_f32_16x16x32_bf16 v[48:51], v[120:123], v[28:31], 0
    v_add_f32_dpp v17, v45, v44 quad_perm:[1,0,3,2] row_mask:0xf bank_mask:0xf
    v_add_f32_dpp v18, v47, v46 quad_perm:[1,0,3,2] row_mask:0xf bank_mask:0xf
    s_nop 1
    v_add_f32_dpp v6, v18, v17 quad_perm:[2,3,0,1] row_mask:0xf bank_mask:0xf
    v_exp_f32 v14, v14
    v_exp_f32 v16, v16
    v_exp_f32 v15, v15
    v_fma_f32 v11, v11, v16, v14
    v_add_f32 v11, v11, v15
    s_waitcnt vmcnt(5)
    buffer_load_dwordx4 v[96:99], v1, s[20:23], s52 offen offset:1280 nt
    v_mfma_f32_16x16x32_bf16 v[44:47], v[124:127], v[28:31], 0
    v_add_f32_dpp v17, v48, v49 quad_perm:[1,0,3,2] row_mask:0xf bank_mask:0xf
    v_add_f32_dpp v18, v50, v51 quad_perm:[1,0,3,2] row_mask:0xf bank_mask:0xf
    s_nop 1
    v_add_f32_dpp v19, v18, v17 quad_perm:[2,3,0,1] row_mask:0xf bank_mask:0xf
    v_cndmask_b32 v6, v6, v19, s[60:61]
    v_mfma_f32_16x16x32_bf16 v[48:51], v[128:131], v[28:31], 0
    s_nop 0
    v_add_f32_dpp v17, v47, v46 quad_perm:[1,0,3,2] row_mask:0xf bank_mask:0xf
    v_add_f32_dpp v18, v45, v44 quad_perm:[1,0,3,2] row_mask:0xf bank_mask:0xf
    s_nop 1
    v_add_f32_dpp v19, v18, v17 quad_perm:[2,3,0,1] row_mask:0xf bank_mask:0xf
    v_cndmask_b32 v6, v6, v19, s[62:63]
    v_mfma_f32_16x16x32_bf16 v[44:47], v[132:135], v[28:31], 0
    v_add_f32_dpp v17, v50, v51 quad_perm:[1,0,3,2] row_mask:0xf bank_mask:0xf
L_pad6:
    s_cbranch_execz L_pad7
    v_add_f32_dpp v18, v48, v49 quad_perm:[1,0,3,2] row_mask:0xf bank_mask:0xf
    s_nop 1
    v_add_f32_dpp v19, v18, v17 quad_perm:[2,3,0,1] row_mask:0xf bank_mask:0xf
    v_cndmask_b32 v6, v6, v19, s[64:65]
    v_cvt_pk_bf16_f32 v6, 0, v6
    v_mul_f32 v6, 0x3db504f3, v6
    v_cvt_pk_bf16_f32 v6, 0, v6
    s_waitcnt vmcnt(5)
    s_mov_b32 s52, 0x700000
    buffer_load_dwordx4 v[100:103], v1, s[20:23], s52 offen nt
    v_mfma_f32_16x16x32_bf16 v[48:51], v[136:139], v[28:31], 0
    v_add_f32_dpp v17, v45, v44 quad_perm:[1,0,3,2] row_mask:0xf bank_mask:0xf
    v_add_f32_dpp v18, v47, v46 quad_perm:[1,0,3,2] row_mask:0xf bank_mask:0xf
    s_nop 1
    v_add_f32_dpp v7, v18, v17 quad_perm:[2,3,0,1] row_mask:0xf bank_mask:0xf
    v_mfma_f32_16x16x32_bf16 v[44:47], v[140:143], v[28:31], 0
    s_nop 1
    v_add_f32_dpp v17, v48, v49 quad_perm:[1,0,3,2] row_mask:0xf bank_mask:0xf
    v_add_f32_dpp v18, v50, v51 quad_perm:[1,0,3,2] row_mask:0xf bank_mask:0xf
    s_nop 1
    v_add_f32_dpp v19, v18, v17 quad_perm:[2,3,0,1] row_mask:0xf bank_mask:0xf
    v_cndmask_b32 v7, v7, v19, s[60:61]
    v_mfma_f32_16x16x32_bf16 v[48:51], v[144:147], v[28:31], 0
    v_add_f32_dpp v17, v47, v46 quad_perm:[1,0,3,2] row_mask:0xf bank_mask:0xf
    v_add_f32_dpp v18, v45, v44 quad_perm:[1,0,3,2] row_mask:0xf bank_mask:0xf
    s_nop 1
    v_add_f32_dpp v19, v18, v17 quad_perm:[2,3,0,1] row_mask:0xf bank_mask:0xf
    v_cndmask_b32 v7, v7, v19, s[62:63]
    s_waitcnt vmcnt(5)
    buffer_load_dwordx4 v[104:107], v1, s[20:23], s52 offen offset:256 nt
    v_mfma_f32_16x16x32_bf16 v[44:47], v[148:151], v[28:31], 0
    v_add_f32_dpp v17, v50, v51 quad_perm:[1,0,3,2] row_mask:0xf bank_mask:0xf
    v_add_f32_dpp v18, v48, v49 quad_perm:[1,0,3,2] row_mask:0xf bank_mask:0xf
    s_nop 1
    v_add_f32_dpp v19, v18, v17 quad_perm:[2,3,0,1] row_mask:0xf bank_mask:0xf
    v_cndmask_b32 v7, v7, v19, s[64:65]
    v_cvt_pk_bf16_f32 v7, 0, v7
    v_mul_f32 v7, 0x3db504f3, v7
    v_cvt_pk_bf16_f32 v7, 0, v7
    v_mul_f32 v16, s55, v10
    v_max3_f32 v10, v6, v7, v10
    ds_write_b64 v12, v[6:7]
    v_mul_f32 v20, s55, v10
    v_add_u32 v12, 512, v12
    v_fma_f32 v14, v6, s55, -v20
    v_fma_f32 v15, v7, s55, -v20
    v_sub_f32 v16, v16, v20
    v_mfma_f32_16x16x32_bf16 v[48:51], v[152:155], v[28:31], 0
    v_add_f32_dpp v17, v45, v44 quad_perm:[1,0,3,2] row_mask:0xf bank_mask:0xf
    v_add_f32_dpp v18, v47, v46 quad_perm:[1,0,3,2] row_mask:0xf bank_mask:0xf
    s_nop 1
    v_add_f32_dpp v6, v18, v17 quad_perm:[2,3,0,1] row_mask:0xf bank_mask:0xf
    v_exp_f32 v14, v14
    v_exp_f32 v16, v16
    v_exp_f32 v15, v15
    v_fma_f32 v11, v11, v16, v14
    v_add_f32 v11, v11, v15
    v_mfma_f32_16x16x32_bf16 v[44:47], v[156:159], v[28:31], 0
    v_add_f32_dpp v17, v48, v49 quad_perm:[1,0,3,2] row_mask:0xf bank_mask:0xf
    v_add_f32_dpp v18, v50, v51 quad_perm:[1,0,3,2] row_mask:0xf bank_mask:0xf
    s_nop 1
    v_add_f32_dpp v19, v18, v17 quad_perm:[2,3,0,1] row_mask:0xf bank_mask:0xf
    v_cndmask_b32 v6, v6, v19, s[60:61]
    s_waitcnt vmcnt(5)
    buffer_load_dwordx4 v[108:111], v1, s[20:23], s52 offen offset:1024 nt
    v_mfma_f32_16x16x32_bf16 v[48:51], v[160:163], v[28:31], 0
    v_add_f32_dpp v17, v47, v46 quad_perm:[1,0,3,2] row_mask:0xf bank_mask:0xf
    v_add_f32_dpp v18, v45, v44 quad_perm:[1,0,3,2] row_mask:0xf bank_mask:0xf
    s_nop 1
    v_add_f32_dpp v19, v18, v17 quad_perm:[2,3,0,1] row_mask:0xf bank_mask:0xf
    v_cndmask_b32 v6, v6, v19, s[62:63]
    v_mfma_f32_16x16x32_bf16 v[44:47], v[164:167], v[28:31], 0
    s_nop 0
    v_add_f32_dpp v17, v50, v51 quad_perm:[1,0,3,2] row_mask:0xf bank_mask:0xf
    v_add_f32_dpp v18, v48, v49 quad_perm:[1,0,3,2] row_mask:0xf bank_mask:0xf
    s_nop 1
    v_add_f32_dpp v19, v18, v17 quad_perm:[2,3,0,1] row_mask:0xf bank_mask:0xf
    v_cndmask_b32 v6, v6, v19, s[64:65]
    v_cvt_pk_bf16_f32 v6, 0, v6
    v_mul_f32 v6, 0x3db504f3, v6
    v_cvt_pk_bf16_f32 v6, 0, v6
    v_mfma_f32_16x16x32_bf16 v[48:51], v[168:171], v[28:31], 0
    v_add_f32_dpp v17, v45, v44 quad_perm:[1,0,3,2] row_mask:0xf bank_mask:0xf
    v_add_f32_dpp v18, v47, v46 quad_perm:[1,0,3,2] row_mask:0xf bank_mask:0xf
    s_nop 1
    v_add_f32_dpp v7, v18, v17 quad_perm:[2,3,0,1] row_mask:0xf bank_mask:0xf
    s_waitcnt vmcnt(5)
    buffer_load_dwordx4 v[112:115], v1, s[20:23], s52 offen offset:1280 nt
    v_mfma_f32_16x16x32_bf16 v[44:47], v[172:175], v[28:31], 0
    v_add_f32_dpp v17, v48, v49 quad_perm:[1,0,3,2] row_mask:0xf bank_mask:0xf
    v_add_f32_dpp v18, v50, v51 quad_perm:[1,0,3,2] row_mask:0xf bank_mask:0xf
    s_nop 1
    v_add_f32_dpp v19, v18, v17 quad_perm:[2,3,0,1] row_mask:0xf bank_mask:0xf
    v_cndmask_b32 v7, v7, v19, s[60:61]
    v_mfma_f32_16x16x32_bf16 v[48:51], v[176:179], v[28:31], 0
    s_nop 0
L_pad7:
    s_cbranch_execz L_pad8
    v_add_f32_dpp v17, v47, v46 quad_perm:[1,0,3,2] row_mask:0xf bank_mask:0xf
    v_add_f32_dpp v18, v45, v44 quad_perm:[1,0,3,2] row_mask:0xf bank_mask:0xf
    s_nop 1
    v_add_f32_dpp v19, v18, v17 quad_perm:[2,3,0,1] row_mask:0xf bank_mask:0xf
    v_cndmask_b32 v7, v7, v19, s[62:63]
    v_mfma_f32_16x16x32_bf16 v[44:47], v[180:183], v[28:31], 0
    v_add_f32_dpp v17, v50, v51 quad_perm:[1,0,3,2] row_mask:0xf bank_mask:0xf
    v_add_f32_dpp v18, v48, v49 quad_perm:[1,0,3,2] row_mask:0xf bank_mask:0xf
    s_nop 1
    v_add_f32_dpp v19, v18, v17 quad_perm:[2,3,0,1] row_mask:0xf bank_mask:0xf
    v_cndmask_b32 v7, v7, v19, s[64:65]
    v_cvt_pk_bf16_f32 v7, 0, v7
    v_mul_f32 v7, 0x3db504f3, v7
    v_cvt_pk_bf16_f32 v7, 0, v7
    v_mul_f32 v16, s55, v10
    v_max3_f32 v10, v6, v7, v10
    ds_write_b64 v12, v[6:7]
    v_mul_f32 v20, s55, v10
    v_add_u32 v12, 512, v12
    v_fma_f32 v14, v6, s55, -v20
    v_fma_f32 v15, v7, s55, -v20
    v_sub_f32 v16, v16, v20
    s_waitcnt vmcnt(5)
    s_mov_b32 s52, 0x180000
    buffer_load_dwordx4 v[116:119], v1, s[20:23], s52 offen nt
    v_mfma_f32_16x16x32_bf16 v[48:51], v[184:187], v[28:31], 0
    v_add_f32_dpp v17, v45, v44 quad_perm:[1,0,3,2] row_mask:0xf bank_mask:0xf
    v_add_f32_dpp v18, v47, v46 quad_perm:[1,0,3,2] row_mask:0xf bank_mask:0xf
    s_nop 1
    v_add_f32_dpp v6, v18, v17 quad_perm:[2,3,0,1] row_mask:0xf bank_mask:0xf
    v_exp_f32 v14, v14
    v_exp_f32 v16, v16
    v_exp_f32 v15, v15
    v_fma_f32 v11, v11, v16, v14
    v_add_f32 v11, v11, v15
    v_mfma_f32_16x16x32_bf16 v[44:47], v[188:191], v[28:31], 0
    v_add_f32_dpp v17, v48, v49 quad_perm:[1,0,3,2] row_mask:0xf bank_mask:0xf
    v_add_f32_dpp v18, v50, v51 quad_perm:[1,0,3,2] row_mask:0xf bank_mask:0xf
    s_nop 1
    v_add_f32_dpp v19, v18, v17 quad_perm:[2,3,0,1] row_mask:0xf bank_mask:0xf
    v_cndmask_b32 v6, v6, v19, s[60:61]
    v_mfma_f32_16x16x32_bf16 v[48:51], v[192:195], v[28:31], 0
    s_nop 0
    v_add_f32_dpp v17, v47, v46 quad_perm:[1,0,3,2] row_mask:0xf bank_mask:0xf
    v_add_f32_dpp v18, v45, v44 quad_perm:[1,0,3,2] row_mask:0xf bank_mask:0xf
    s_nop 1
    v_add_f32_dpp v19, v18, v17 quad_perm:[2,3,0,1] row_mask:0xf bank_mask:0xf
    v_cndmask_b32 v6, v6, v19, s[62:63]
    s_waitcnt vmcnt(5)
    buffer_load_dwordx4 v[120:123], v1, s[20:23], s52 offen offset:256 nt
    v_mfma_f32_16x16x32_bf16 v[44:47], v[196:199], v[28:31], 0
    v_add_f32_dpp v17, v50, v51 quad_perm:[1,0,3,2] row_mask:0xf bank_mask:0xf
    v_add_f32_dpp v18, v48, v49 quad_perm:[1,0,3,2] row_mask:0xf bank_mask:0xf
    s_nop 1
    v_add_f32_dpp v19, v18, v17 quad_perm:[2,3,0,1] row_mask:0xf bank_mask:0xf
    v_cndmask_b32 v6, v6, v19, s[64:65]
    v_cvt_pk_bf16_f32 v6, 0, v6
    v_mul_f32 v6, 0x3db504f3, v6
    v_cvt_pk_bf16_f32 v6, 0, v6
    v_mfma_f32_16x16x32_bf16 v[48:51], v[200:203], v[28:31], 0
    v_add_f32_dpp v17, v45, v44 quad_perm:[1,0,3,2] row_mask:0xf bank_mask:0xf
    v_add_f32_dpp v18, v47, v46 quad_perm:[1,0,3,2] row_mask:0xf bank_mask:0xf
    s_nop 1
    v_add_f32_dpp v7, v18, v17 quad_perm:[2,3,0,1] row_mask:0xf bank_mask:0xf
    v_mfma_f32_16x16x32_bf16 v[44:47], v[204:207], v[28:31], 0
    s_nop 1
    v_add_f32_dpp v17, v48, v49 quad_perm:[1,0,3,2] row_mask:0xf bank_mask:0xf
    v_add_f32_dpp v18, v50, v51 quad_perm:[1,0,3,2] row_mask:0xf bank_mask:0xf
    s_nop 1
    v_add_f32_dpp v19, v18, v17 quad_perm:[2,3,0,1] row_mask:0xf bank_mask:0xf
    v_cndmask_b32 v7, v7, v19, s[60:61]
    s_waitcnt vmcnt(5)
    buffer_load_dwordx4 v[124:127], v1, s[20:23], s52 offen offset:1024 nt
    v_mfma_f32_16x16x32_bf16 v[48:51], v[208:211], v[28:31], 0
    v_add_f32_dpp v17, v47, v46 quad_perm:[1,0,3,2] row_mask:0xf bank_mask:0xf
    v_add_f32_dpp v18, v45, v44 quad_perm:[1,0,3,2] row_mask:0xf bank_mask:0xf
    s_nop 1
    v_add_f32_dpp v19, v18, v17 quad_perm:[2,3,0,1] row_mask:0xf bank_mask:0xf
    v_cndmask_b32 v7, v7, v19, s[62:63]
    v_mfma_f32_16x16x32_bf16 v[44:47], v[212:215], v[28:31], 0
    s_nop 0
    v_add_f32_dpp v17, v50, v51 quad_perm:[1,0,3,2] row_mask:0xf bank_mask:0xf
    v_add_f32_dpp v18, v48, v49 quad_perm:[1,0,3,2] row_mask:0xf bank_mask:0xf
    s_nop 1
    v_add_f32_dpp v19, v18, v17 quad_perm:[2,3,0,1] row_mask:0xf bank_mask:0xf
    v_cndmask_b32 v7, v7, v19, s[64:65]
    v_cvt_pk_bf16_f32 v7, 0, v7
    v_mul_f32 v7, 0x3db504f3, v7
    v_cvt_pk_bf16_f32 v7, 0, v7
    v_mul_f32 v16, s55, v10
    v_max3_f32 v10, v6, v7, v10
    ds_write_b64 v12, v[6:7]
    v_mul_f32 v20, s55, v10
    v_add_u32 v12, 512, v12
    v_fma_f32 v14, v6, s55, -v20
    v_fma_f32 v15, v7, s55, -v20
L_pad8:
    s_cbranch_execz L_pad9
    v_sub_f32 v16, v16, v20
    v_mfma_f32_16x16x32_bf16 v[48:51], v[216:219], v[28:31], 0
    v_add_f32_dpp v17, v45, v44 quad_perm:[1,0,3,2] row_mask:0xf bank_mask:0xf
    v_add_f32_dpp v18, v47, v46 quad_perm:[1,0,3,2] row_mask:0xf bank_mask:0xf
    s_nop 1
    v_add_f32_dpp v6, v18, v17 quad_perm:[2,3,0,1] row_mask:0xf bank_mask:0xf
    v_exp_f32 v14, v14
    v_exp_f32 v16, v16
    v_exp_f32 v15, v15
    v_fma_f32 v11, v11, v16, v14
    v_add_f32 v11, v11, v15
    s_waitcnt vmcnt(5)
    buffer_load_dwordx4 v[128:131], v1, s[20:23], s52 offen offset:1280 nt
    v_mfma_f32_16x16x32_bf16 v[44:47], v[220:223], v[28:31], 0
    v_add_f32_dpp v17, v48, v49 quad_perm:[1,0,3,2] row_mask:0xf bank_mask:0xf
    v_add_f32_dpp v18, v50, v51 quad_perm:[1,0,3,2] row_mask:0xf bank_mask:0xf
    s_nop 1
    v_add_f32_dpp v19, v18, v17 quad_perm:[2,3,0,1] row_mask:0xf bank_mask:0xf
    v_cndmask_b32 v6, v6, v19, s[60:61]
    v_mfma_f32_16x16x32_bf16 v[48:51], v[224:227], v[28:31], 0
    s_nop 0
    v_add_f32_dpp v17, v47, v46 quad_perm:[1,0,3,2] row_mask:0xf bank_mask:0xf
    v_add_f32_dpp v18, v45, v44 quad_perm:[1,0,3,2] row_mask:0xf bank_mask:0xf
    s_nop 1
    v_add_f32_dpp v19, v18, v17 quad_perm:[2,3,0,1] row_mask:0xf bank_mask:0xf
    v_cndmask_b32 v6, v6, v19, s[62:63]
    v_mfma_f32_16x16x32_bf16 v[44:47], v[228:231], v[28:31], 0
    v_add_f32_dpp v17, v50, v51 quad_perm:[1,0,3,2] row_mask:0xf bank_mask:0xf
    v_add_f32_dpp v18, v48, v49 quad_perm:[1,0,3,2] row_mask:0xf bank_mask:0xf
    s_nop 1
    v_add_f32_dpp v19, v18, v17 quad_perm:[2,3,0,1] row_mask:0xf bank_mask:0xf
    v_cndmask_b32 v6, v6, v19, s[64:65]
    v_cvt_pk_bf16_f32 v6, 0, v6
    v_mul_f32 v6, 0x3db504f3, v6
    v_cvt_pk_bf16_f32 v6, 0, v6
    s_waitcnt vmcnt(5)
    s_mov_b32 s52, 0x580000
    buffer_load_dwordx4 v[132:135], v1, s[20:23], s52 offen nt
    v_mfma_f32_16x16x32_bf16 v[48:51], v[232:235], v[28:31], 0
    v_add_f32_dpp v17, v45, v44 quad_perm:[1,0,3,2] row_mask:0xf bank_mask:0xf
    v_add_f32_dpp v18, v47, v46 quad_perm:[1,0,3,2] row_mask:0xf bank_mask:0xf
    s_nop 1
    v_add_f32_dpp v7, v18, v17 quad_perm:[2,3,0,1] row_mask:0xf bank_mask:0xf
    v_mfma_f32_16x16x32_bf16 v[44:47], v[236:239], v[28:31], 0
    s_nop 1
    v_add_f32_dpp v17, v48, v49 quad_perm:[1,0,3,2] row_mask:0xf bank_mask:0xf
    v_add_f32_dpp v18, v50, v51 quad_perm:[1,0,3,2] row_mask:0xf bank_mask:0xf
    s_nop 1
    v_add_f32_dpp v19, v18, v17 quad_perm:[2,3,0,1] row_mask:0xf bank_mask:0xf
    v_cndmask_b32 v7, v7, v19, s[60:61]
    v_mfma_f32_16x16x32_bf16 v[48:51], v[240:243], v[28:31], 0
    v_add_f32_dpp v17, v47, v46 quad_perm:[1,0,3,2] row_mask:0xf bank_mask:0xf
    v_add_f32_dpp v18, v45, v44 quad_perm:[1,0,3,2] row_mask:0xf bank_mask:0xf
    s_nop 1
    v_add_f32_dpp v19, v18, v17 quad_perm:[2,3,0,1] row_mask:0xf bank_mask:0xf
    v_cndmask_b32 v7, v7, v19, s[62:63]
    s_waitcnt vmcnt(5)
    buffer_load_dwordx4 v[136:139], v1, s[20:23], s52 offen offset:256 nt
    v_mfma_f32_16x16x32_bf16 v[44:47], v[84:87], v[28:31], 0
    v_add_f32_dpp v17, v50, v51 quad_perm:[1,0,3,2] row_mask:0xf bank_mask:0xf
    v_add_f32_dpp v18, v48, v49 quad_perm:[1,0,3,2] row_mask:0xf bank_mask:0xf
    s_nop 1
    v_add_f32_dpp v19, v18, v17 quad_perm:[2,3,0,1] row_mask:0xf bank_mask:0xf
    v_cndmask_b32 v7, v7, v19, s[64:65]
    v_cvt_pk_bf16_f32 v7, 0, v7
    v_mul_f32 v7, 0x3db504f3, v7
    v_cvt_pk_bf16_f32 v7, 0, v7
    v_mul_f32 v16, s55, v10
    v_max3_f32 v10, v6, v7, v10
    ds_write_b64 v12, v[6:7]
    v_mul_f32 v20, s55, v10
    v_add_u32 v12, 512, v12
    v_fma_f32 v14, v6, s55, -v20
    v_fma_f32 v15, v7, s55, -v20
    v_sub_f32 v16, v16, v20
    v_mfma_f32_16x16x32_bf16 v[48:51], v[88:91], v[28:31], 0
    v_add_f32_dpp v17, v45, v44 quad_perm:[1,0,3,2] row_mask:0xf bank_mask:0xf
    v_add_f32_dpp v18, v47, v46 quad_perm:[1,0,3,2] row_mask:0xf bank_mask:0xf
    s_nop 1
    v_add_f32_dpp v6, v18, v17 quad_perm:[2,3,0,1] row_mask:0xf bank_mask:0xf
    v_exp_f32 v14, v14
    v_exp_f32 v16, v16
    v_exp_f32 v15, v15
    v_fma_f32 v11, v11, v16, v14
    v_add_f32 v11, v11, v15
    v_mfma_f32_16x16x32_bf16 v[44:47], v[92:95], v[28:31], 0
    v_add_f32_dpp v17, v48, v49 quad_perm:[1,0,3,2] row_mask:0xf bank_mask:0xf
    v_add_f32_dpp v18, v50, v51 quad_perm:[1,0,3,2] row_mask:0xf bank_mask:0xf
    s_nop 1
    v_add_f32_dpp v19, v18, v17 quad_perm:[2,3,0,1] row_mask:0xf bank_mask:0xf
    v_cndmask_b32 v6, v6, v19, s[60:61]
    s_waitcnt vmcnt(5)
    buffer_load_dwordx4 v[140:143], v1, s[20:23], s52 offen offset:1024 nt
    v_mfma_f32_16x16x32_bf16 v[48:51], v[96:99], v[28:31], 0
    v_add_f32_dpp v17, v47, v46 quad_perm:[1,0,3,2] row_mask:0xf bank_mask:0xf
    v_add_f32_dpp v18, v45, v44 quad_perm:[1,0,3,2] row_mask:0xf bank_mask:0xf
L_pad9:
    s_cbranch_execz L_pad10
    s_nop 1
    v_add_f32_dpp v19, v18, v17 quad_perm:[2,3,0,1] row_mask:0xf bank_mask:0xf
    v_cndmask_b32 v6, v6, v19, s[62:63]
    v_mfma_f32_16x16x32_bf16 v[44:47], v[100:103], v[28:31], 0
    s_nop 0
    v_add_f32_dpp v17, v50, v51 quad_perm:[1,0,3,2] row_mask:0xf bank_mask:0xf
    v_add_f32_dpp v18, v48, v49 quad_perm:[1,0,3,2] row_mask:0xf bank_mask:0xf
    s_nop 1
    v_add_f32_dpp v19, v18, v17 quad_perm:[2,3,0,1] row_mask:0xf bank_mask:0xf
    v_cndmask_b32 v6, v6, v19, s[64:65]
    v_cvt_pk_bf16_f32 v6, 0, v6
    v_mul_f32 v6, 0x3db504f3, v6
    v_cvt_pk_bf16_f32 v6, 0, v6
    v_mfma_f32_16x16x32_bf16 v[48:51], v[104:107], v[28:31], 0
    v_add_f32_dpp v17, v45, v44 quad_perm:[1,0,3,2] row_mask:0xf bank_mask:0xf
    v_add_f32_dpp v18, v47, v46 quad_perm:[1,0,3,2] row_mask:0xf bank_mask:0xf
    s_nop 1
    v_add_f32_dpp v7, v18, v17 quad_perm:[2,3,0,1] row_mask:0xf bank_mask:0xf
    s_waitcnt vmcnt(5)
    buffer_load_dwordx4 v[144:147], v1, s[20:23], s52 offen offset:1280 nt
    v_mfma_f32_16x16x32_bf16 v[44:47], v[108:111], v[28:31], 0
    v_add_f32_dpp v17, v48, v49 quad_perm:[1,0,3,2] row_mask:0xf bank_mask:0xf
    v_add_f32_dpp v18, v50, v51 quad_perm:[1,0,3,2] row_mask:0xf bank_mask:0xf
    s_nop 1
    v_add_f32_dpp v19, v18, v17 quad_perm:[2,3,0,1] row_mask:0xf bank_mask:0xf
    v_cndmask_b32 v7, v7, v19, s[60:61]
    v_mfma_f32_16x16x32_bf16 v[48:51], v[112:115], v[28:31], 0
    s_nop 0
    v_add_f32_dpp v17, v47, v46 quad_perm:[1,0,3,2] row_mask:0xf bank_mask:0xf
    v_add_f32_dpp v18, v45, v44 quad_perm:[1,0,3,2] row_mask:0xf bank_mask:0xf
    s_nop 1
    v_add_f32_dpp v19, v18, v17 quad_perm:[2,3,0,1] row_mask:0xf bank_mask:0xf
    v_cndmask_b32 v7, v7, v19, s[62:63]
    v_mfma_f32_16x16x32_bf16 v[44:47], v[116:119], v[28:31], 0
    v_add_f32_dpp v17, v50, v51 quad_perm:[1,0,3,2] row_mask:0xf bank_mask:0xf
    v_add_f32_dpp v18, v48, v49 quad_perm:[1,0,3,2] row_mask:0xf bank_mask:0xf
    s_nop 1
    v_add_f32_dpp v19, v18, v17 quad_perm:[2,3,0,1] row_mask:0xf bank_mask:0xf
    v_cndmask_b32 v7, v7, v19, s[64:65]
    v_cvt_pk_bf16_f32 v7, 0, v7
    v_mul_f32 v7, 0x3db504f3, v7
    v_cvt_pk_bf16_f32 v7, 0, v7
    v_mul_f32 v16, s55, v10
    v_max3_f32 v10, v6, v7, v10
    ds_write_b64 v12, v[6:7]
    v_mul_f32 v20, s55, v10
    v_add_u32 v12, 512, v12
    v_fma_f32 v14, v6, s55, -v20
    v_fma_f32 v15, v7, s55, -v20
    v_sub_f32 v16, v16, v20
    s_waitcnt vmcnt(5)
    s_mov_b32 s52, 0x380000
    buffer_load_dwordx4 v[84:87], v1, s[20:23], s52 offen nt
    v_mfma_f32_16x16x32_bf16 v[48:51], v[120:123], v[28:31], 0
    v_add_f32_dpp v17, v45, v44 quad_perm:[1,0,3,2] row_mask:0xf bank_mask:0xf
    v_add_f32_dpp v18, v47, v46 quad_perm:[1,0,3,2] row_mask:0xf bank_mask:0xf
    s_nop 1
    v_add_f32_dpp v6, v18, v17 quad_perm:[2,3,0,1] row_mask:0xf bank_mask:0xf
    v_exp_f32 v14, v14
    v_exp_f32 v16, v16
    v_exp_f32 v15, v15
    v_fma_f32 v11, v11, v16, v14
    v_add_f32 v11, v11, v15
    v_mfma_f32_16x16x32_bf16 v[44:47], v[124:127], v[28:31], 0
    v_add_f32_dpp v17, v48, v49 quad_perm:[1,0,3,2] row_mask:0xf bank_mask:0xf
    v_add_f32_dpp v18, v50, v51 quad_perm:[1,0,3,2] row_mask:0xf bank_mask:0xf
    s_nop 1
    v_add_f32_dpp v19, v18, v17 quad_perm:[2,3,0,1] row_mask:0xf bank_mask:0xf
    v_cndmask_b32 v6, v6, v19, s[60:61]
    s_waitcnt vmcnt(5)
    buffer_load_dwordx4 v[88:91], v1, s[20:23], s52 offen offset:256 nt
    v_mfma_f32_16x16x32_bf16 v[48:51], v[128:131], v[28:31], 0
    v_add_f32_dpp v17, v47, v46 quad_perm:[1,0,3,2] row_mask:0xf bank_mask:0xf
    v_add_f32_dpp v18, v45, v44 quad_perm:[1,0,3,2] row_mask:0xf bank_mask:0xf
    s_nop 1
    v_add_f32_dpp v19, v18, v17 quad_perm:[2,3,0,1] row_mask:0xf bank_mask:0xf
    v_cndmask_b32 v6, v6, v19, s[62:63]
    s_waitcnt vmcnt(5)
    buffer_load_dwordx4 v[92:95], v1, s[20:23], s52 offen offset:1024 nt
    v_mfma_f32_16x16x32_bf16 v[44:47], v[132:135], v[28:31], 0
    v_add_f32_dpp v17, v50, v51 quad_perm:[1,0,3,2] row_mask:0xf bank_mask:0xf
    v_add_f32_dpp v18, v48, v49 quad_perm:[1,0,3,2] row_mask:0xf bank_mask:0xf
    s_nop 1
    v_add_f32_dpp v19, v18, v17 quad_perm:[2,3,0,1] row_mask:0xf bank_mask:0xf
    v_cndmask_b32 v6, v6, v19, s[64:65]
    v_cvt_pk_bf16_f32 v6, 0, v6
    v_mul_f32 v6, 0x3db504f3, v6
    v_cvt_pk_bf16_f32 v6, 0, v6
    s_waitcnt vmcnt(5)
    buffer_load_dwordx4 v[96:99], v1, s[20:23], s52 offen offset:1280 nt
    v_mfma_f32_16x16x32_bf16 v[48:51], v[136:139], v[28:31], 0
    v_add_f32_dpp v17, v45, v44 quad_perm:[1,0,3,2] row_mask:0xf bank_mask:0xf
    v_add_f32_dpp v18, v47, v46 quad_perm:[1,0,3,2] row_mask:0xf bank_mask:0xf
    s_nop 1
    v_add_f32_dpp v7, v18, v17 quad_perm:[2,3,0,1] row_mask:0xf bank_mask:0xf
    s_waitcnt vmcnt(5)
L_pad10:
    s_cbranch_execz L_pad11
    s_mov_b32 s52, 0x780000
    buffer_load_dwordx4 v[100:103], v1, s[20:23], s52 offen nt
    v_mfma_f32_16x16x32_bf16 v[44:47], v[140:143], v[28:31], 0
    v_add_f32_dpp v17, v48, v49 quad_perm:[1,0,3,2] row_mask:0xf bank_mask:0xf
    v_add_f32_dpp v18, v50, v51 quad_perm:[1,0,3,2] row_mask:0xf bank_mask:0xf
    s_nop 1
    v_add_f32_dpp v19, v18, v17 quad_perm:[2,3,0,1] row_mask:0xf bank_mask:0xf
    v_cndmask_b32 v7, v7, v19, s[60:61]
    s_waitcnt vmcnt(5)
    buffer_load_dwordx4 v[104:107], v1, s[20:23], s52 offen offset:256 nt
    v_mfma_f32_16x16x32_bf16 v[48:51], v[144:147], v[28:31], 0
    v_add_f32_dpp v17, v47, v46 quad_perm:[1,0,3,2] row_mask:0xf bank_mask:0xf
    v_add_f32_dpp v18, v45, v44 quad_perm:[1,0,3,2] row_mask:0xf bank_mask:0xf
    s_nop 1
    v_add_f32_dpp v19, v18, v17 quad_perm:[2,3,0,1] row_mask:0xf bank_mask:0xf
    v_cndmask_b32 v7, v7, v19, s[62:63]
    s_waitcnt vmcnt(5)
    buffer_load_dwordx4 v[108:111], v1, s[20:23], s52 offen offset:1024 nt
    v_mfma_f32_16x16x32_bf16 v[44:47], v[84:87], v[28:31], 0
    v_add_f32_dpp v17, v50, v51 quad_perm:[1,0,3,2] row_mask:0xf bank_mask:0xf
    v_add_f32_dpp v18, v48, v49 quad_perm:[1,0,3,2] row_mask:0xf bank_mask:0xf
    s_nop 1
    v_add_f32_dpp v19, v18, v17 quad_perm:[2,3,0,1] row_mask:0xf bank_mask:0xf
    v_cndmask_b32 v7, v7, v19, s[64:65]
    v_cvt_pk_bf16_f32 v7, 0, v7
    v_mul_f32 v7, 0x3db504f3, v7
    v_cvt_pk_bf16_f32 v7, 0, v7
    v_mul_f32 v16, s55, v10
    v_max3_f32 v10, v6, v7, v10
    ds_write_b64 v12, v[6:7]
    v_mul_f32 v20, s55, v10
    v_add_u32 v12, 512, v12
    v_fma_f32 v14, v6, s55, -v20
    v_fma_f32 v15, v7, s55, -v20
    v_sub_f32 v16, v16, v20
    s_waitcnt vmcnt(5)
    buffer_load_dwordx4 v[112:115], v1, s[20:23], s52 offen offset:1280 nt
    v_mfma_f32_16x16x32_bf16 v[48:51], v[88:91], v[28:31], 0
    v_add_f32_dpp v17, v45, v44 quad_perm:[1,0,3,2] row_mask:0xf bank_mask:0xf
    v_add_f32_dpp v18, v47, v46 quad_perm:[1,0,3,2] row_mask:0xf bank_mask:0xf
    s_nop 1
    v_add_f32_dpp v6, v18, v17 quad_perm:[2,3,0,1] row_mask:0xf bank_mask:0xf
    v_exp_f32 v14, v14
    v_exp_f32 v16, v16
    v_exp_f32 v15, v15
    v_fma_f32 v11, v11, v16, v14
    v_add_f32 v11, v11, v15
    s_mov_b32 s53, 8
    s_mov_b32 s73, 0x20000
.p2align 6
L_kloop:
    v_subrev_u32 v72, s74, v25
    s_add_u32 s74, s74, 1
    v_cmp_gt_u32 vcc, 64, v72
    v_mov_b32 v24, s74
    s_bcnt1_i32_b64 s4, vcc
    buffer_store_dword v24, v22, s[36:39], 0 offen
    buffer_load_dword v25, v23, s[36:39], 0 offen nt
    s_sub_u32 s5, s74, s72
    s_cmp_lt_u32 s5, 2
    s_cbranch_scc1 L_kctl
L_kctlb:
    s_cmp_ge_u32 s4, s75
    s_cbranch_scc1 L_khi
    s_waitcnt vmcnt(6)
    buffer_load_dwordx4 v[84:87], v1, s[20:23], s73 offen nt
    v_mfma_f32_16x16x32_bf16 v[44:47], v[92:95], v[28:31], 0
    v_add_f32_dpp v17, v48, v49 quad_perm:[1,0,3,2] row_mask:0xf bank_mask:0xf
    v_add_f32_dpp v18, v50, v51 quad_perm:[1,0,3,2] row_mask:0xf bank_mask:0xf
    s_nop 1
    v_add_f32_dpp v19, v18, v17 quad_perm:[2,3,0,1] row_mask:0xf bank_mask:0xf
    v_cndmask_b32 v6, v6, v19, s[60:61]
    s_waitcnt vmcnt(6)
    buffer_load_dwordx4 v[88:91], v1, s[20:23], s73 offen offset:256 nt
    v_mfma_f32_16x16x32_bf16 v[48:51], v[96:99], v[28:31], 0
    v_add_f32_dpp v17, v47, v46 quad_perm:[1,0,3,2] row_mask:0xf bank_mask:0xf
    v_add_f32_dpp v18, v45, v44 quad_perm:[1,0,3,2] row_mask:0xf bank_mask:0xf
    s_nop 1
    v_add_f32_dpp v19, v18, v17 quad_perm:[2,3,0,1] row_mask:0xf bank_mask:0xf
    v_cndmask_b32 v6, v6, v19, s[62:63]
    s_waitcnt vmcnt(6)
    buffer_load_dwordx4 v[92:95], v1, s[20:23], s73 offen offset:1024 nt
    v_mfma_f32_16x16x32_bf16 v[44:47], v[100:103], v[28:31], 0
    v_add_f32_dpp v17, v50, v51 quad_perm:[1,0,3,2] row_mask:0xf bank_mask:0xf
    v_add_f32_dpp v18, v48, v49 quad_perm:[1,0,3,2] row_mask:0xf bank_mask:0xf
    s_nop 1
    v_add_f32_dpp v19, v18, v17 quad_perm:[2,3,0,1] row_mask:0xf bank_mask:0xf
    v_cndmask_b32 v6, v6, v19, s[64:65]
    v_cvt_pk_bf16_f32 v6, 0, v6
    v_mul_f32 v6, 0x3db504f3, v6
    v_cvt_pk_bf16_f32 v6, 0, v6
    s_waitcnt vmcnt(6)
    buffer_load_dwordx4 v[96:99], v1, s[20:23], s73 offen offset:1280 nt
    v_mfma_f32_16x16x32_bf16 v[48:51], v[104:107], v[28:31], 0
    v_add_f32_dpp v17, v45, v44 quad_perm:[1,0,3,2] row_mask:0xf bank_mask:0xf
    v_add_f32_dpp v18, v47, v46 quad_perm:[1,0,3,2] row_mask:0xf bank_mask:0xf
    s_nop 1
    v_add_f32_dpp v7, v18, v17 quad_perm:[2,3,0,1] row_mask:0xf bank_mask:0xf
    s_xor_b32 s52, s73, 0x400000
L_pad11:
    s_cbranch_execz L_pad12
    s_waitcnt vmcnt(6)
    buffer_load_dwordx4 v[100:103], v1, s[20:23], s52 offen nt
    v_mfma_f32_16x16x32_bf16 v[44:47], v[108:111], v[28:31], 0
    v_add_f32_dpp v17, v48, v49 quad_perm:[1,0,3,2] row_mask:0xf bank_mask:0xf
    v_add_f32_dpp v18, v50, v51 quad_perm:[1,0,3,2] row_mask:0xf bank_mask:0xf
    s_nop 1
    v_add_f32_dpp v19, v18, v17 quad_perm:[2,3,0,1] row_mask:0xf bank_mask:0xf
    v_cndmask_b32 v7, v7, v19, s[60:61]
    s_waitcnt vmcnt(4)
    buffer_load_dwordx4 v[104:107], v1, s[20:23], s52 offen offset:256 nt
    v_mfma_f32_16x16x32_bf16 v[48:51], v[112:115], v[28:31], 0
    v_add_f32_dpp v17, v47, v46 quad_perm:[1,0,3,2] row_mask:0xf bank_mask:0xf
    v_add_f32_dpp v18, v45, v44 quad_perm:[1,0,3,2] row_mask:0xf bank_mask:0xf
    s_nop 1
    v_add_f32_dpp v19, v18, v17 quad_perm:[2,3,0,1] row_mask:0xf bank_mask:0xf
    v_cndmask_b32 v7, v7, v19, s[62:63]
    s_waitcnt vmcnt(4)
    buffer_load_dwordx4 v[108:111], v1, s[20:23], s52 offen offset:1024 nt
    v_mfma_f32_16x16x32_bf16 v[44:47], v[84:87], v[28:31], 0
    v_add_f32_dpp v17, v50, v51 quad_perm:[1,0,3,2] row_mask:0xf bank_mask:0xf
    v_add_f32_dpp v18, v48, v49 quad_perm:[1,0,3,2] row_mask:0xf bank_mask:0xf
    s_nop 1
    v_add_f32_dpp v19, v18, v17 quad_perm:[2,3,0,1] row_mask:0xf bank_mask:0xf
    v_cndmask_b32 v7, v7, v19, s[64:65]
    v_cvt_pk_bf16_f32 v7, 0, v7
    v_mul_f32 v7, 0x3db504f3, v7
    v_cvt_pk_bf16_f32 v7, 0, v7
    v_mul_f32 v16, s55, v10
    v_max3_f32 v10, v6, v7, v10
    ds_write_b64 v12, v[6:7]
    v_mul_f32 v20, s55, v10
    v_add_u32 v12, 512, v12
    v_fma_f32 v14, v6, s55, -v20
    v_fma_f32 v15, v7, s55, -v20
    v_sub_f32 v16, v16, v20
    s_waitcnt vmcnt(4)
    buffer_load_dwordx4 v[112:115], v1, s[20:23], s52 offen offset:1280 nt
    s_add_u32 s53, s53, 1
    s_and_b32 s73, s53, 1
    s_lshl_b32 s73, s73, 21
    s_and_b32 s4, s53, 6
    s_lshl_b32 s4, s4, 18
    s_add_u32 s73, s73, s4
    s_and_b32 s4, s53, 8
    s_lshl_b32 s4, s4, 14
    s_add_u32 s73, s73, s4
    v_mfma_f32_16x16x32_bf16 v[48:51], v[88:91], v[28:31], 0
    v_add_f32_dpp v17, v45, v44 quad_perm:[1,0,3,2] row_mask:0xf bank_mask:0xf
    v_add_f32_dpp v18, v47, v46 quad_perm:[1,0,3,2] row_mask:0xf bank_mask:0xf
    s_nop 1
    v_add_f32_dpp v6, v18, v17 quad_perm:[2,3,0,1] row_mask:0xf bank_mask:0xf
    v_exp_f32 v14, v14
    v_exp_f32 v16, v16
    v_exp_f32 v15, v15
    v_fma_f32 v11, v11, v16, v14
    v_add_f32 v11, v11, v15
    s_cmp_lg_u32 s53, 16
    s_cbranch_scc1 L_kloop
    s_branch L_kdone
L_khi:
    v_add_u32 v72, -1, v72
    v_cmp_gt_u32 vcc, 63, v72
    s_bcnt1_i32_b32 s4, vcc_lo
    s_cmp_ge_u32 s4, 8
    s_cbranch_scc1 L_kturbo
    s_waitcnt vmcnt(7)
    buffer_load_dwordx4 v[84:87], v1, s[20:23], s73 offen nt
    v_mfma_f32_16x16x32_bf16 v[44:47], v[92:95], v[28:31], 0
    v_add_f32_dpp v17, v48, v49 quad_perm:[1,0,3,2] row_mask:0xf bank_mask:0xf
    v_add_f32_dpp v18, v50, v51 quad_perm:[1,0,3,2] row_mask:0xf bank_mask:0xf
    s_nop 1
    v_add_f32_dpp v19, v18, v17 quad_perm:[2,3,0,1] row_mask:0xf bank_mask:0xf
    v_cndmask_b32 v6, v6, v19, s[60:61]
    s_waitcnt vmcnt(7)
    buffer_load_dwordx4 v[88:91], v1, s[20:23], s73 offen offset:256 nt
    v_mfma_f32_16x16x32_bf16 v[48:51], v[96:99], v[28:31], 0
    v_add_f32_dpp v17, v47, v46 quad_perm:[1,0,3,2] row_mask:0xf bank_mask:0xf
    v_add_f32_dpp v18, v45, v44 quad_perm:[1,0,3,2] row_mask:0xf bank_mask:0xf
    s_nop 1
    v_add_f32_dpp v19, v18, v17 quad_perm:[2,3,0,1] row_mask:0xf bank_mask:0xf
    v_cndmask_b32 v6, v6, v19, s[62:63]
    s_waitcnt vmcnt(7)
    buffer_load_dwordx4 v[92:95], v1, s[20:23], s73 offen offset:1024 nt
    v_mfma_f32_16x16x32_bf16 v[44:47], v[100:103], v[28:31], 0
    v_add_f32_dpp v17, v50, v51 quad_perm:[1,0,3,2] row_mask:0xf bank_mask:0xf
    v_add_f32_dpp v18, v48, v49 quad_perm:[1,0,3,2] row_mask:0xf bank_mask:0xf
    s_nop 1
    v_add_f32_dpp v19, v18, v17 quad_perm:[2,3,0,1] row_mask:0xf bank_mask:0xf
    v_cndmask_b32 v6, v6, v19, s[64:65]
    v_cvt_pk_bf16_f32 v6, 0, v6
    v_mul_f32 v6, 0x3db504f3, v6
    v_cvt_pk_bf16_f32 v6, 0, v6
    s_waitcnt vmcnt(7)
    buffer_load_dwordx4 v[96:99], v1, s[20:23], s73 offen offset:1280 nt
    v_mfma_f32_16x16x32_bf16 v[48:51], v[104:107], v[28:31], 0
    v_add_f32_dpp v17, v45, v44 quad_perm:[1,0,3,2] row_mask:0xf bank_mask:0xf
    v_add_f32_dpp v18, v47, v46 quad_perm:[1,0,3,2] row_mask:0xf bank_mask:0xf
L_pad12:
    s_cbranch_execz L_pad13
    s_nop 1
    v_add_f32_dpp v7, v18, v17 quad_perm:[2,3,0,1] row_mask:0xf bank_mask:0xf
    s_xor_b32 s52, s73, 0x400000
    s_waitcnt vmcnt(7)
    buffer_load_dwordx4 v[100:103], v1, s[20:23], s52 offen nt
    v_mfma_f32_16x16x32_bf16 v[44:47], v[108:111], v[28:31], 0
    v_add_f32_dpp v17, v48, v49 quad_perm:[1,0,3,2] row_mask:0xf bank_mask:0xf
    v_add_f32_dpp v18, v50, v51 quad_perm:[1,0,3,2] row_mask:0xf bank_mask:0xf
    s_nop 1
    v_add_f32_dpp v19, v18, v17 quad_perm:[2,3,0,1] row_mask:0xf bank_mask:0xf
    v_cndmask_b32 v7, v7, v19, s[60:61]
    s_waitcnt vmcnt(7)
    buffer_load_dwordx4 v[104:107], v1, s[20:23], s52 offen offset:256 nt
    v_mfma_f32_16x16x32_bf16 v[48:51], v[112:115], v[28:31], 0
    v_add_f32_dpp v17, v47, v46 quad_perm:[1,0,3,2] row_mask:0xf bank_mask:0xf
    v_add_f32_dpp v18, v45, v44 quad_perm:[1,0,3,2] row_mask:0xf bank_mask:0xf
    s_nop 1
    v_add_f32_dpp v19, v18, v17 quad_perm:[2,3,0,1] row_mask:0xf bank_mask:0xf
    v_cndmask_b32 v7, v7, v19, s[62:63]
    s_waitcnt vmcnt(5)
    buffer_load_dwordx4 v[108:111], v1, s[20:23], s52 offen offset:1024 nt
    v_mfma_f32_16x16x32_bf16 v[44:47], v[84:87], v[28:31], 0
    v_add_f32_dpp v17, v50, v51 quad_perm:[1,0,3,2] row_mask:0xf bank_mask:0xf
    v_add_f32_dpp v18, v48, v49 quad_perm:[1,0,3,2] row_mask:0xf bank_mask:0xf
    s_nop 1
    v_add_f32_dpp v19, v18, v17 quad_perm:[2,3,0,1] row_mask:0xf bank_mask:0xf
    v_cndmask_b32 v7, v7, v19, s[64:65]
    v_cvt_pk_bf16_f32 v7, 0, v7
    v_mul_f32 v7, 0x3db504f3, v7
    v_cvt_pk_bf16_f32 v7, 0, v7
    v_mul_f32 v16, s55, v10
    v_max3_f32 v10, v6, v7, v10
    ds_write_b64 v12, v[6:7]
    v_mul_f32 v20, s55, v10
    v_add_u32 v12, 512, v12
    v_fma_f32 v14, v6, s55, -v20
    v_fma_f32 v15, v7, s55, -v20
    v_sub_f32 v16, v16, v20
    s_waitcnt vmcnt(5)
    buffer_load_dwordx4 v[112:115], v1, s[20:23], s52 offen offset:1280 nt
    s_add_u32 s53, s53, 1
    s_and_b32 s73, s53, 1
    s_lshl_b32 s73, s73, 21
    s_and_b32 s4, s53, 6
    s_lshl_b32 s4, s4, 18
    s_add_u32 s73, s73, s4
    s_and_b32 s4, s53, 8
    s_lshl_b32 s4, s4, 14
    s_add_u32 s73, s73, s4
    v_mfma_f32_16x16x32_bf16 v[48:51], v[88:91], v[28:31], 0
    v_add_f32_dpp v17, v45, v44 quad_perm:[1,0,3,2] row_mask:0xf bank_mask:0xf
    v_add_f32_dpp v18, v47, v46 quad_perm:[1,0,3,2] row_mask:0xf bank_mask:0xf
    s_nop 1
    v_add_f32_dpp v6, v18, v17 quad_perm:[2,3,0,1] row_mask:0xf bank_mask:0xf
    v_exp_f32 v14, v14
    v_exp_f32 v16, v16
    v_exp_f32 v15, v15
    v_fma_f32 v11, v11, v16, v14
    v_add_f32 v11, v11, v15
    s_cmp_lg_u32 s53, 16
    s_cbranch_scc1 L_kloop
L_kdone:
    s_waitcnt vmcnt(4)
    buffer_load_dwordx4 v[84:87], v2, s[24:27], 0 offen nt
    v_mfma_f32_16x16x32_bf16 v[44:47], v[92:95], v[28:31], 0
    v_add_f32_dpp v17, v48, v49 quad_perm:[1,0,3,2] row_mask:0xf bank_mask:0xf
    v_add_f32_dpp v18, v50, v51 quad_perm:[1,0,3,2] row_mask:0xf bank_mask:0xf
    s_nop 1
    v_add_f32_dpp v19, v18, v17 quad_perm:[2,3,0,1] row_mask:0xf bank_mask:0xf
    v_cndmask_b32 v6, v6, v19, s[60:61]
    v_subrev_u32 v80, 7680, v12
    ds_read_b64 v[8:9], v80
    s_waitcnt vmcnt(4)
    buffer_load_dwordx4 v[88:91], v2, s[24:27], 0 offen offset:256 nt
    v_mfma_f32_16x16x32_bf16 v[48:51], v[96:99], v[28:31], 0
    v_add_f32_dpp v17, v47, v46 quad_perm:[1,0,3,2] row_mask:0xf bank_mask:0xf
    v_add_f32_dpp v18, v45, v44 quad_perm:[1,0,3,2] row_mask:0xf bank_mask:0xf
    s_nop 1
    v_add_f32_dpp v19, v18, v17 quad_perm:[2,3,0,1] row_mask:0xf bank_mask:0xf
    v_cndmask_b32 v6, v6, v19, s[62:63]
    v_mov_b32 v36, 0
    v_mov_b32 v37, 0
    v_mov_b32 v38, 0
    v_mov_b32 v39, 0
    v_mov_b32 v40, 0
    v_mov_b32 v41, 0
    v_mov_b32 v42, 0
    v_mov_b32 v43, 0
    s_waitcnt vmcnt(4)
    buffer_load_dwordx4 v[92:95], v2, s[24:27], 0 offen offset:1024 nt
    v_mfma_f32_16x16x32_bf16 v[44:47], v[100:103], v[28:31], 0
    v_add_f32_dpp v17, v50, v51 quad_perm:[1,0,3,2] row_mask:0xf bank_mask:0xf
    v_add_f32_dpp v18, v48, v49 quad_perm:[1,0,3,2] row_mask:0xf bank_mask:0xf
    s_nop 1
    v_add_f32_dpp v19, v18, v17 quad_perm:[2,3,0,1] row_mask:0xf bank_mask:0xf
    v_cndmask_b32 v6, v6, v19, s[64:65]
    v_cvt_pk_bf16_f32 v6, 0, v6
L_pad13:
    s_cbranch_execz L_pad14
    v_mul_f32 v6, 0x3db504f3, v6
    v_cvt_pk_bf16_f32 v6, 0, v6
    s_waitcnt vmcnt(4)
    buffer_load_dwordx4 v[96:99], v2, s[24:27], 0 offen offset:1280 nt
    v_mfma_f32_16x16x32_bf16 v[48:51], v[104:107], v[28:31], 0
    v_add_f32_dpp v17, v45, v44 quad_perm:[1,0,3,2] row_mask:0xf bank_mask:0xf
    v_add_f32_dpp v18, v47, v46 quad_perm:[1,0,3,2] row_mask:0xf bank_mask:0xf
    s_nop 1
    v_add_f32_dpp v7, v18, v17 quad_perm:[2,3,0,1] row_mask:0xf bank_mask:0xf
    s_waitcnt vmcnt(4)
    s_mov_b32 s52, 0x400000
    buffer_load_dwordx4 v[100:103], v2, s[24:27], s52 offen nt
    v_mfma_f32_16x16x32_bf16 v[44:47], v[108:111], v[28:31], 0
    v_add_f32_dpp v17, v48, v49 quad_perm:[1,0,3,2] row_mask:0xf bank_mask:0xf
    v_add_f32_dpp v18, v50, v51 quad_perm:[1,0,3,2] row_mask:0xf bank_mask:0xf
    s_nop 1
    v_add_f32_dpp v19, v18, v17 quad_perm:[2,3,0,1] row_mask:0xf bank_mask:0xf
    v_cndmask_b32 v7, v7, v19, s[60:61]
    s_waitcnt vmcnt(4)
    buffer_load_dwordx4 v[104:107], v2, s[24:27], s52 offen offset:256 nt
    v_mfma_f32_16x16x32_bf16 v[48:51], v[112:115], v[28:31], 0
    v_add_f32_dpp v17, v47, v46 quad_perm:[1,0,3,2] row_mask:0xf bank_mask:0xf
    v_add_f32_dpp v18, v45, v44 quad_perm:[1,0,3,2] row_mask:0xf bank_mask:0xf
    s_nop 1
    v_add_f32_dpp v19, v18, v17 quad_perm:[2,3,0,1] row_mask:0xf bank_mask:0xf
    v_cndmask_b32 v7, v7, v19, s[62:63]
    buffer_load_dwordx4 v[108:111], v2, s[24:27], s52 offen offset:1024 nt
    buffer_load_dwordx4 v[112:115], v2, s[24:27], s52 offen offset:1280 nt
    v_add_f32_dpp v17, v50, v51 quad_perm:[1,0,3,2] row_mask:0xf bank_mask:0xf
    v_add_f32_dpp v18, v48, v49 quad_perm:[1,0,3,2] row_mask:0xf bank_mask:0xf
    s_nop 1
    v_add_f32_dpp v19, v18, v17 quad_perm:[2,3,0,1] row_mask:0xf bank_mask:0xf
    v_cndmask_b32 v7, v7, v19, s[64:65]
    v_cvt_pk_bf16_f32 v7, 0, v7
    v_mul_f32 v7, 0x3db504f3, v7
    v_cvt_pk_bf16_f32 v7, 0, v7
    v_mul_f32 v16, s55, v10
    v_max3_f32 v10, v6, v7, v10
    ds_write_b64 v12, v[6:7]
    v_mul_f32 v20, s55, v10
    v_add_u32 v12, 512, v12
    v_fma_f32 v14, v6, s55, -v20
    v_fma_f32 v15, v7, s55, -v20
    v_sub_f32 v16, v16, v20
    v_mov_b32 v19, v20
    v_mov_b32 v12, v80
    v_max_f32_dpp v10, v10, v10 quad_perm:[1,0,3,2] row_mask:0xf bank_mask:0xf
    s_nop 1
    v_max_f32_dpp v10, v10, v10 quad_perm:[2,3,0,1] row_mask:0xf bank_mask:0xf
    v_mov_b32 v17, v10
    s_nop 1
    v_permlane16_swap_b32 v17, v10
    v_max_f32 v10, v10, v17
    v_mov_b32 v17, v10
    s_nop 1
    v_permlane32_swap_b32 v17, v10
    v_max_f32 v10, v10, v17
    v_mul_f32 v13, s55, v10
    s_waitcnt lgkmcnt(0)
    v_fma_f32 v20, v8, s55, -v13
    v_exp_f32 v20, v20
    s_nop 0
    v_cvt_pk_bf16_f32 v21, v20, v20
    s_nop 1
    v_and_b32_dpp v54, v21, v4 quad_perm:[0,0,0,0] row_mask:0xf bank_mask:0xf
    v_and_b32_dpp v55, v21, v5 quad_perm:[0,0,0,0] row_mask:0xf bank_mask:0xf
    s_waitcnt vmcnt(7)
    s_nop 0
    v_mfma_f32_16x16x32_bf16 v[36:39], v[84:87], v[54:57], v[36:39]
    v_mfma_f32_16x16x32_bf16 v[40:43], v[84:87], v[52:55], v[40:43]
    v_and_b32_dpp v58, v21, v4 quad_perm:[1,1,1,1] row_mask:0xf bank_mask:0xf
    v_and_b32_dpp v59, v21, v5 quad_perm:[1,1,1,1] row_mask:0xf bank_mask:0xf
    v_exp_f32 v14, v14
    v_exp_f32 v16, v16
    v_exp_f32 v15, v15
    v_fma_f32 v11, v11, v16, v14
    v_add_f32 v11, v11, v15
    v_sub_f32 v19, v19, v13
    v_exp_f32 v19, v19
    s_lshl_b32 s5, s59, 11
    s_lshl_b32 s4, s3, 9
    v_mul_f32 v11, v11, v19
    s_add_u32 s4, s4, s5
    v_lshl_add_u32 v79, v0, 3, s4
    v_add_f32_dpp v11, v11, v11 quad_perm:[1,0,3,2] row_mask:0xf bank_mask:0xf
    s_nop 1
    v_add_f32_dpp v11, v11, v11 quad_perm:[2,3,0,1] row_mask:0xf bank_mask:0xf
    v_mov_b32 v17, v11
    s_nop 1
    v_permlane16_swap_b32 v17, v11
    v_add_f32 v11, v11, v17
    v_mov_b32 v17, v11
    s_nop 1
    v_permlane32_swap_b32 v17, v11
    v_add_f32 v11, v11, v17
    ds_write_b64 v79, v[10:11] offset:49152
L_pad14:
    s_cbranch_execz L_pad15
    v_lshl_add_u32 v80, v0, 3, s5
    s_waitcnt vmcnt(6)
    v_mfma_f32_16x16x32_bf16 v[36:39], v[88:91], v[58:61], v[36:39]
    v_mfma_f32_16x16x32_bf16 v[40:43], v[88:91], v[56:59], v[40:43]
    v_and_b32_dpp v62, v21, v4 quad_perm:[2,2,2,2] row_mask:0xf bank_mask:0xf
    v_and_b32_dpp v63, v21, v5 quad_perm:[2,2,2,2] row_mask:0xf bank_mask:0xf
    s_waitcnt lgkmcnt(0)
    s_barrier
    s_cmp_eq_u32 s3, 3
    s_cbranch_scc1 L_pubml
    s_lshl_b32 s4, s59, 1
    s_cmp_lt_u32 s3, s4
    s_cbranch_scc1 L_puba
L_vent:
    s_mov_b32 s53, 1
    s_mov_b32 s73, 0x200000
.p2align 6
L_vloop:
    v_subrev_u32 v72, s74, v25
    s_add_u32 s74, s74, 1
    v_cmp_gt_u32 vcc, 64, v72
    v_mov_b32 v24, s74
    s_bcnt1_i32_b64 s4, vcc
    buffer_store_dword v24, v22, s[36:39], 0 offen
    buffer_load_dword v25, v23, s[36:39], 0 offen nt
    s_sub_u32 s5, s74, s72
    s_cmp_lt_u32 s5, 2
    s_cbranch_scc1 L_vctl
L_vctlb:
    s_cmp_eq_u32 s53, 12
    s_cbranch_scc1 L_side
    s_cmp_ge_u32 s4, s75
    s_cbranch_scc1 L_vhi
    s_waitcnt vmcnt(6)
    buffer_load_dwordx4 v[84:87], v2, s[24:27], s73 offen nt
    v_mfma_f32_16x16x32_bf16 v[36:39], v[92:95], v[62:65], v[36:39]
    v_mfma_f32_16x16x32_bf16 v[40:43], v[92:95], v[60:63], v[40:43]
    v_and_b32_dpp v66, v21, v4 quad_perm:[3,3,3,3] row_mask:0xf bank_mask:0xf
    v_and_b32_dpp v67, v21, v5 quad_perm:[3,3,3,3] row_mask:0xf bank_mask:0xf
    s_waitcnt vmcnt(6)
    buffer_load_dwordx4 v[88:91], v2, s[24:27], s73 offen offset:256 nt
    v_mfma_f32_16x16x32_bf16 v[36:39], v[96:99], v[66:69], v[36:39]
    v_mfma_f32_16x16x32_bf16 v[40:43], v[96:99], v[64:67], v[40:43]
    v_fma_f32 v20, v9, s55, -v13
    v_exp_f32 v20, v20
    v_add_u32 v12, 512, v12
    ds_read_b64 v[8:9], v12
    v_cvt_pk_bf16_f32 v21, v20, v20
    s_nop 1
    v_and_b32_dpp v54, v21, v4 quad_perm:[0,0,0,0] row_mask:0xf bank_mask:0xf
    v_and_b32_dpp v55, v21, v5 quad_perm:[0,0,0,0] row_mask:0xf bank_mask:0xf
    s_waitcnt vmcnt(6)
    buffer_load_dwordx4 v[92:95], v2, s[24:27], s73 offen offset:1024 nt
    v_mfma_f32_16x16x32_bf16 v[36:39], v[100:103], v[54:57], v[36:39]
    v_mfma_f32_16x16x32_bf16 v[40:43], v[100:103], v[52:55], v[40:43]
    v_and_b32_dpp v58, v21, v4 quad_perm:[1,1,1,1] row_mask:0xf bank_mask:0xf
    v_and_b32_dpp v59, v21, v5 quad_perm:[1,1,1,1] row_mask:0xf bank_mask:0xf
    s_waitcnt vmcnt(6)
    buffer_load_dwordx4 v[96:99], v2, s[24:27], s73 offen offset:1280 nt
    v_mfma_f32_16x16x32_bf16 v[36:39], v[104:107], v[58:61], v[36:39]
    v_mfma_f32_16x16x32_bf16 v[40:43], v[104:107], v[56:59], v[40:43]
    v_and_b32_dpp v62, v21, v4 quad_perm:[2,2,2,2] row_mask:0xf bank_mask:0xf
    v_and_b32_dpp v63, v21, v5 quad_perm:[2,2,2,2] row_mask:0xf bank_mask:0xf
    s_xor_b32 s52, s73, 0x400000
    s_waitcnt vmcnt(6)
    buffer_load_dwordx4 v[100:103], v2, s[24:27], s52 offen nt
    v_mfma_f32_16x16x32_bf16 v[36:39], v[108:111], v[62:65], v[36:39]
    v_mfma_f32_16x16x32_bf16 v[40:43], v[108:111], v[60:63], v[40:43]
    v_and_b32_dpp v66, v21, v4 quad_perm:[3,3,3,3] row_mask:0xf bank_mask:0xf
    v_and_b32_dpp v67, v21, v5 quad_perm:[3,3,3,3] row_mask:0xf bank_mask:0xf
    s_waitcnt vmcnt(4)
    buffer_load_dwordx4 v[104:107], v2, s[24:27], s52 offen offset:256 nt
    v_mfma_f32_16x16x32_bf16 v[36:39], v[112:115], v[66:69], v[36:39]
    v_mfma_f32_16x16x32_bf16 v[40:43], v[112:115], v[64:67], v[40:43]
    s_waitcnt lgkmcnt(0)
    v_fma_f32 v20, v8, s55, -v13
    v_exp_f32 v20, v20
    s_nop 0
    v_cvt_pk_bf16_f32 v21, v20, v20
    s_nop 1
    v_and_b32_dpp v54, v21, v4 quad_perm:[0,0,0,0] row_mask:0xf bank_mask:0xf
    v_and_b32_dpp v55, v21, v5 quad_perm:[0,0,0,0] row_mask:0xf bank_mask:0xf
    s_waitcnt vmcnt(4)
    buffer_load_dwordx4 v[108:111], v2, s[24:27], s52 offen offset:1024 nt
    v_mfma_f32_16x16x32_bf16 v[36:39], v[84:87], v[54:57], v[36:39]
    v_mfma_f32_16x16x32_bf16 v[40:43], v[84:87], v[52:55], v[40:43]
    v_and_b32_dpp v58, v21, v4 quad_perm:[1,1,1,1] row_mask:0xf bank_mask:0xf
    v_and_b32_dpp v59, v21, v5 quad_perm:[1,1,1,1] row_mask:0xf bank_mask:0xf
    s_waitcnt vmcnt(4)
    buffer_load_dwordx4 v[112:115], v2, s[24:27], s52 offen offset:1280 nt
    s_add_u32 s53, s53, 1
    s_and_b32 s73, s53, 1
    s_lshl_b32 s73, s73, 21
    s_and_b32 s4, s53, 6
    s_lshl_b32 s4, s4, 18
    s_add_u32 s73, s73, s4
    s_and_b32 s4, s53, 8
    s_lshl_b32 s4, s4, 14
    s_add_u32 s73, s73, s4
    v_mfma_f32_16x16x32_bf16 v[36:39], v[88:91], v[58:61], v[36:39]
L_pad15:
    s_cbranch_execz L_pad16
    v_mfma_f32_16x16x32_bf16 v[40:43], v[88:91], v[56:59], v[40:43]
    v_and_b32_dpp v62, v21, v4 quad_perm:[2,2,2,2] row_mask:0xf bank_mask:0xf
    v_and_b32_dpp v63, v21, v5 quad_perm:[2,2,2,2] row_mask:0xf bank_mask:0xf
    s_cmp_lg_u32 s53, 16
    s_cbranch_scc1 L_vloop
    s_branch L_vdone
L_vhi:
    v_add_u32 v72, -1, v72
    v_cmp_gt_u32 vcc, 63, v72
    s_bcnt1_i32_b32 s4, vcc_lo
    s_cmp_ge_u32 s4, 8
    s_cbranch_scc1 L_vturbo
    s_waitcnt vmcnt(7)
    buffer_load_dwordx4 v[84:87], v2, s[24:27], s73 offen nt
    v_mfma_f32_16x16x32_bf16 v[36:39], v[92:95], v[62:65], v[36:39]
    v_mfma_f32_16x16x32_bf16 v[40:43], v[92:95], v[60:63], v[40:43]
    v_and_b32_dpp v66, v21, v4 quad_perm:[3,3,3,3] row_mask:0xf bank_mask:0xf
    v_and_b32_dpp v67, v21, v5 quad_perm:[3,3,3,3] row_mask:0xf bank_mask:0xf
    s_waitcnt vmcnt(7)
    buffer_load_dwordx4 v[88:91], v2, s[24:27], s73 offen offset:256 nt
    v_mfma_f32_16x16x32_bf16 v[36:39], v[96:99], v[66:69], v[36:39]
    v_mfma_f32_16x16x32_bf16 v[40:43], v[96:99], v[64:67], v[40:43]
    v_fma_f32 v20, v9, s55, -v13
    v_exp_f32 v20, v20
    v_add_u32 v12, 512, v12
    ds_read_b64 v[8:9], v12
    v_cvt_pk_bf16_f32 v21, v20, v20
    s_nop 1
    v_and_b32_dpp v54, v21, v4 quad_perm:[0,0,0,0] row_mask:0xf bank_mask:0xf
    v_and_b32_dpp v55, v21, v5 quad_perm:[0,0,0,0] row_mask:0xf bank_mask:0xf
    s_waitcnt vmcnt(7)
    buffer_load_dwordx4 v[92:95], v2, s[24:27], s73 offen offset:1024 nt
    v_mfma_f32_16x16x32_bf16 v[36:39], v[100:103], v[54:57], v[36:39]
    v_mfma_f32_16x16x32_bf16 v[40:43], v[100:103], v[52:55], v[40:43]
    v_and_b32_dpp v58, v21, v4 quad_perm:[1,1,1,1] row_mask:0xf bank_mask:0xf
    v_and_b32_dpp v59, v21, v5 quad_perm:[1,1,1,1] row_mask:0xf bank_mask:0xf
    s_waitcnt vmcnt(7)
    buffer_load_dwordx4 v[96:99], v2, s[24:27], s73 offen offset:1280 nt
    v_mfma_f32_16x16x32_bf16 v[36:39], v[104:107], v[58:61], v[36:39]
    v_mfma_f32_16x16x32_bf16 v[40:43], v[104:107], v[56:59], v[40:43]
    v_and_b32_dpp v62, v21, v4 quad_perm:[2,2,2,2] row_mask:0xf bank_mask:0xf
    v_and_b32_dpp v63, v21, v5 quad_perm:[2,2,2,2] row_mask:0xf bank_mask:0xf
    s_xor_b32 s52, s73, 0x400000
    s_waitcnt vmcnt(7)
    buffer_load_dwordx4 v[100:103], v2, s[24:27], s52 offen nt
    v_mfma_f32_16x16x32_bf16 v[36:39], v[108:111], v[62:65], v[36:39]
    v_mfma_f32_16x16x32_bf16 v[40:43], v[108:111], v[60:63], v[40:43]
    v_and_b32_dpp v66, v21, v4 quad_perm:[3,3,3,3] row_mask:0xf bank_mask:0xf
    v_and_b32_dpp v67, v21, v5 quad_perm:[3,3,3,3] row_mask:0xf bank_mask:0xf
    s_waitcnt vmcnt(7)
    buffer_load_dwordx4 v[104:107], v2, s[24:27], s52 offen offset:256 nt
    v_mfma_f32_16x16x32_bf16 v[36:39], v[112:115], v[66:69], v[36:39]
    v_mfma_f32_16x16x32_bf16 v[40:43], v[112:115], v[64:67], v[40:43]
    s_waitcnt lgkmcnt(0)
    v_fma_f32 v20, v8, s55, -v13
    v_exp_f32 v20, v20
    s_nop 0
    v_cvt_pk_bf16_f32 v21, v20, v20
    s_nop 1
    v_and_b32_dpp v54, v21, v4 quad_perm:[0,0,0,0] row_mask:0xf bank_mask:0xf
    v_and_b32_dpp v55, v21, v5 quad_perm:[0,0,0,0] row_mask:0xf bank_mask:0xf
    s_waitcnt vmcnt(5)
    buffer_load_dwordx4 v[108:111], v2, s[24:27], s52 offen offset:1024 nt
    v_mfma_f32_16x16x32_bf16 v[36:39], v[84:87], v[54:57], v[36:39]
    v_mfma_f32_16x16x32_bf16 v[40:43], v[84:87], v[52:55], v[40:43]
    v_and_b32_dpp v58, v21, v4 quad_perm:[1,1,1,1] row_mask:0xf bank_mask:0xf
    v_and_b32_dpp v59, v21, v5 quad_perm:[1,1,1,1] row_mask:0xf bank_mask:0xf
    s_waitcnt vmcnt(5)
    buffer_load_dwordx4 v[112:115], v2, s[24:27], s52 offen offset:1280 nt
    s_add_u32 s53, s53, 1
    s_and_b32 s73, s53, 1
    s_lshl_b32 s73, s73, 21
    s_and_b32 s4, s53, 6
    s_lshl_b32 s4, s4, 18
    s_add_u32 s73, s73, s4
    s_and_b32 s4, s53, 8
    s_lshl_b32 s4, s4, 14
    s_add_u32 s73, s73, s4
    v_mfma_f32_16x16x32_bf16 v[36:39], v[88:91], v[58:61], v[36:39]
    v_mfma_f32_16x16x32_bf16 v[40:43], v[88:91], v[56:59], v[40:43]
    v_and_b32_dpp v62, v21, v4 quad_perm:[2,2,2,2] row_mask:0xf bank_mask:0xf
    v_and_b32_dpp v63, v21, v5 quad_perm:[2,2,2,2] row_mask:0xf bank_mask:0xf
    s_cmp_lg_u32 s53, 16
    s_cbranch_scc1 L_vloop
L_vdone:
L_mlchk:
    v_xor_b32 v164, s68, v164
    v_xor_b32 v165, s69, v165
    v_xor_b32 v166, s70, v166
    v_xor_b32 v167, s71, v167
    v_or_b32 v81, v164, v165
    v_or3_b32 v81, v166, v167, v81
    v_and_b32 v81, 0xff, v81
    v_cmp_ne_u32 vcc, 0, v81
    s_cbranch_vccnz L_mlretry
    ds_read2st64_b64 v[44:47], v80 offset0:96 offset1:97
    ds_read2st64_b64 v[48:51], v80 offset0:98 offset1:99
    s_cmp_lg_u32 s59, 0
    s_cbranch_scc1 L_epi
L_pad16:
    s_cbranch_execz L_pad17
    s_mov_b32 s20, s76
    s_mov_b32 s21, s77
    s_mov_b32 s24, s78
    s_mov_b32 s25, s79
    s_lshl_b32 s4, s59, 2
    s_add_u32 s4, s4, s3
    s_lshl_b32 s5, s4, 11
    v_add_u32 v79, s5, v3
    s_waitcnt vmcnt(5)
    buffer_load_dwordx4 v[84:87], v1, s[20:23], 0 offen nt
    v_mfma_f32_16x16x32_bf16 v[36:39], v[92:95], v[62:65], v[36:39]
    v_mfma_f32_16x16x32_bf16 v[40:43], v[92:95], v[60:63], v[40:43]
    v_and_b32_dpp v66, v21, v4 quad_perm:[3,3,3,3] row_mask:0xf bank_mask:0xf
    v_and_b32_dpp v67, v21, v5 quad_perm:[3,3,3,3] row_mask:0xf bank_mask:0xf
    v_mov_b32 v166, v164
    s_nop 1
    v_max_f32_dpp v166, v166, v166 quad_perm:[1,0,3,2] row_mask:0xf bank_mask:0xf
    s_nop 1
    v_max_f32_dpp v166, v166, v166 quad_perm:[2,3,0,1] row_mask:0xf bank_mask:0xf
    v_mov_b32 v167, v166
    s_nop 1
    v_permlane16_swap_b32 v167, v166
    v_max_f32 v166, v166, v167
    v_mov_b32 v167, v166
    s_nop 1
    v_permlane32_swap_b32 v167, v166
    v_max_f32 v166, v166, v167
    v_mul_f32 v166, s55, v166
    v_fma_f32 v164, v164, s55, -v166
    s_waitcnt lgkmcnt(0)
    v_fma_f32 v176, v44, s55, -v166
    v_fma_f32 v177, v46, s55, -v166
    v_fma_f32 v178, v48, s55, -v166
    v_fma_f32 v179, v50, s55, -v166
    v_exp_f32 v164, v164
    v_exp_f32 v176, v176
    v_exp_f32 v177, v177
    v_exp_f32 v178, v178
    v_exp_f32 v179, v179
    v_mul_f32 v165, v165, v164
    s_nop 1
    v_add_f32_dpp v165, v165, v165 quad_perm:[1,0,3,2] row_mask:0xf bank_mask:0xf
    s_nop 1
    v_add_f32_dpp v165, v165, v165 quad_perm:[2,3,0,1] row_mask:0xf bank_mask:0xf
    v_mov_b32 v167, v165
    s_nop 1
    v_permlane16_swap_b32 v167, v165
    s_waitcnt vmcnt(5)
    buffer_load_dwordx4 v[88:91], v1, s[20:23], 0 offen offset:256 nt
    v_mfma_f32_16x16x32_bf16 v[36:39], v[96:99], v[66:69], v[36:39]
    v_mfma_f32_16x16x32_bf16 v[40:43], v[96:99], v[64:67], v[40:43]
    v_fma_f32 v20, v9, s55, -v13
    v_exp_f32 v20, v20
    s_nop 0
    v_cvt_pk_bf16_f32 v21, v20, v20
    s_nop 1
    v_and_b32_dpp v54, v21, v4 quad_perm:[0,0,0,0] row_mask:0xf bank_mask:0xf
    v_and_b32_dpp v55, v21, v5 quad_perm:[0,0,0,0] row_mask:0xf bank_mask:0xf
    v_and_b32_dpp v58, v21, v4 quad_perm:[1,1,1,1] row_mask:0xf bank_mask:0xf
    v_and_b32_dpp v59, v21, v5 quad_perm:[1,1,1,1] row_mask:0xf bank_mask:0xf
    v_and_b32_dpp v62, v21, v4 quad_perm:[2,2,2,2] row_mask:0xf bank_mask:0xf
    v_and_b32_dpp v63, v21, v5 quad_perm:[2,2,2,2] row_mask:0xf bank_mask:0xf
    v_and_b32_dpp v66, v21, v4 quad_perm:[3,3,3,3] row_mask:0xf bank_mask:0xf
    v_and_b32_dpp v67, v21, v5 quad_perm:[3,3,3,3] row_mask:0xf bank_mask:0xf
    v_add_f32 v165, v165, v167
    v_mov_b32 v167, v165
    s_nop 1
    v_permlane32_swap_b32 v167, v165
    v_add_f32 v165, v165, v167
    v_rcp_f32 v165, v165
    v_lshlrev_b32 v202, 16, v148
    v_and_b32 v203, 0xffff0000, v148
    v_lshlrev_b32 v210, 16, v152
    v_and_b32 v211, 0xffff0000, v152
    v_lshlrev_b32 v204, 16, v149
    v_and_b32 v205, 0xffff0000, v149
    v_lshlrev_b32 v212, 16, v153
    v_and_b32 v213, 0xffff0000, v153
    v_lshlrev_b32 v206, 16, v150
    v_and_b32 v207, 0xffff0000, v150
    v_lshlrev_b32 v214, 16, v154
    v_and_b32 v215, 0xffff0000, v154
    v_lshlrev_b32 v208, 16, v151
    v_and_b32 v209, 0xffff0000, v151
    v_lshlrev_b32 v216, 16, v155
    v_and_b32 v217, 0xffff0000, v155
    v_mul_f32 v202, v202, v210
    v_mul_f32 v203, v203, v211
    v_mul_f32 v204, v204, v212
    v_mul_f32 v205, v205, v213
    v_mul_f32 v206, v206, v214
    s_waitcnt vmcnt(5)
    buffer_load_dwordx4 v[92:95], v1, s[20:23], 0 offen offset:1024 nt
    v_mfma_f32_16x16x32_bf16 v[36:39], v[100:103], v[54:57], v[36:39]
    v_mfma_f32_16x16x32_bf16 v[40:43], v[100:103], v[52:55], v[40:43]
    v_mul_f32 v207, v207, v215
L_pad17:
    s_cbranch_execz L_pad18
    v_mul_f32 v208, v208, v216
    v_mul_f32 v209, v209, v217
    v_cvt_pk_bf16_f32 v202, 0, v202
    v_cvt_pk_bf16_f32 v203, 0, v203
    v_cvt_pk_bf16_f32 v204, 0, v204
    v_cvt_pk_bf16_f32 v205, 0, v205
    v_cvt_pk_bf16_f32 v206, 0, v206
    v_cvt_pk_bf16_f32 v207, 0, v207
    v_cvt_pk_bf16_f32 v208, 0, v208
    v_cvt_pk_bf16_f32 v209, 0, v209
    v_add_f32 v202, v202, v206
    v_add_f32 v203, v203, v207
    v_add_f32 v204, v204, v208
    v_add_f32 v205, v205, v209
    v_add_f32 v202, v202, v204
    v_add_f32 v203, v203, v205
    v_add_f32 v202, v202, v203
    s_nop 1
    v_add_f32_dpp v202, v202, v202 row_ror:4 row_mask:0xf bank_mask:0xf
    s_nop 1
    v_add_f32_dpp v202, v202, v202 row_ror:8 row_mask:0xf bank_mask:0xf
    s_nop 1
    v_add_f32_dpp v202, v202, v202 quad_perm:[1,0,3,2] row_mask:0xf bank_mask:0xf
    s_nop 1
    v_add_f32_dpp v202, v202, v202 quad_perm:[2,3,0,1] row_mask:0xf bank_mask:0xf
    v_mov_b32 v203, v202
    s_nop 1
    v_permlane16_swap_b32 v203, v202
    v_add_f32 v202, v202, v203
    v_mov_b32 v203, v202
    s_waitcnt vmcnt(5)
    buffer_load_dwordx4 v[96:99], v1, s[20:23], 0 offen offset:1280 nt
    v_mfma_f32_16x16x32_bf16 v[36:39], v[104:107], v[58:61], v[36:39]
    v_mfma_f32_16x16x32_bf16 v[40:43], v[104:107], v[56:59], v[40:43]
    v_permlane32_swap_b32 v203, v202
    v_add_f32 v202, v202, v203
    v_cvt_pk_bf16_f32 v202, 0, v202
    v_mul_f32 v202, 0xbfb8aa3b, v202
    v_exp_f32 v202, v202
    s_nop 0
    v_add_f32 v202, 1.0, v202
    v_rcp_f32 v202, v202
    s_nop 0
    v_cvt_pk_bf16_f32 v174, 0, v202
    v_sub_f32 v175, 1.0, v174
    v_cvt_pk_bf16_f32 v175, 0, v175
    v_mul_f32 v165, v165, v174
    v_mul_f32 v176, v176, v165
    v_mul_f32 v177, v177, v165
    v_mul_f32 v178, v178, v165
    v_mul_f32 v179, v179, v165
    s_lshr_b32 s8, s7, 3
    s_bfe_u32 s9, s7, 0x10002
    s_and_b32 s10, s7, 3
    s_lshl_b32 s12, s6, 2
    s_add_u32 s12, s12, s8
    s_lshl_b32 s12, s12, 2
    s_add_u32 s12, s12, s3
    s_lshl_b32 s12, s12, 3
    s_add_u32 s12, s12, s9
    s_lshl_b32 s12, s12, 4
    s_add_u32 s12, s12, s10
    s_waitcnt vmcnt(5)
    s_mov_b32 s52, 0x400000
    buffer_load_dwordx4 v[100:103], v1, s[20:23], s52 offen nt
    v_mfma_f32_16x16x32_bf16 v[36:39], v[108:111], v[62:65], v[36:39]
    v_mfma_f32_16x16x32_bf16 v[40:43], v[108:111], v[60:63], v[40:43]
    v_mov_b32 v28, v32
    v_mov_b32 v29, v33
    v_mov_b32 v30, v34
    v_mov_b32 v31, v35
    v_mov_b32 v10, 0xff800000
    v_mov_b32 v11, 0
    v_subrev_u32 v12, 7680, v12
    s_lshl_b32 s12, s12, 8
    v_and_b32 v168, 0xff, v3
    v_lshl_add_u32 v168, v76, 10, v168
    v_add_u32 v168, s12, v168
    s_lshl_b32 s13, s3, 10
    v_add_u32 v169, s13, v3
    s_lshl_b32 s12, s6, 16
    s_add_u32 s12, s12, 0x100000
    s_lshl_b32 s13, s3, 13
    s_add_u32 s13, s13, s12
    s_lshr_b32 s14, s3, 1
    s_lshl_b32 s14, s14, 28
    s_add_u32 s13, s13, s14
    s_and_b32 s14, s7, 1
    s_lshl_b32 s14, s14, 10
    s_add_u32 s13, s13, s14
    s_lshr_b32 s14, s7, 1
    s_lshl_b32 s14, s14, 6
    s_add_u32 s13, s13, s14
    v_lshl_add_u32 v170, v75, 14, s13
    v_lshl_add_u32 v170, v76, 11, v170
    v_lshl_add_u32 v170, v77, 4, v170
L_pad18:
    s_cbranch_execz L_pad19
    s_lshr_b32 s11, s7, 2
    s_lshl_b32 s13, s11, 2
    s_add_u32 s13, s13, s3
    s_lshl_b32 s13, s13, 11
    s_waitcnt vmcnt(5)
    buffer_load_dwordx4 v[104:107], v1, s[20:23], s52 offen offset:256 nt
    v_mfma_f32_16x16x32_bf16 v[36:39], v[112:115], v[66:69], v[36:39]
    v_mfma_f32_16x16x32_bf16 v[40:43], v[112:115], v[64:67], v[40:43]
    s_add_u32 s13, s13, s12
    v_bfe_u32 v200, v0, 3, 1
    v_lshl_add_u32 v200, v200, 5, v76
    v_lshlrev_b32 v200, 2, v200
    s_and_b32 s14, s3, 2
    s_lshl_b32 s14, s14, 5
    v_xor_b32 v200, s14, v200
    v_xor_b32 v201, 64, v200
    v_add_u32 v171, s13, v3
    v_add_u32 v26, 0x4000, v26
    s_lshl_b32 s13, s10, 3
    s_add_u32 s13, s13, s6
    s_lshl_b32 s13, s13, 3
    s_add_u32 s13, s13, s11
    s_lshl_b32 s13, s13, 10
    s_add_u32 s16, s13, 0x80000
    s_mov_b32 s17, 0x80000
    s_lshl_b32 s13, s7, 16
    s_lshl_b32 s14, s6, 7
    s_add_u32 s13, s13, s14
    s_add_u32 s13, s13, 0x80000
    s_lshl_b32 s14, s3, 5
    s_add_u32 s13, s13, s14
    v_and_b32 v172, 0x10, v3
    v_lshrrev_b32 v173, 1, v0
    v_lshl_add_u32 v172, v173, 10, v172
    s_waitcnt vmcnt(5)
    buffer_load_dwordx4 v[108:111], v1, s[20:23], s52 offen offset:1024 nt
    v_mfma_f32_16x16x32_bf16 v[44:47], v[84:87], v[28:31], 0
    ds_write_b128 v79, v[36:39] offset:32768
    ds_write_b128 v79, v[40:43] offset:33792
    v_add_u32 v172, s13, v172
    s_and_b32 s13, s2, 1
    s_lshl_b32 s13, s13, 10
    s_lshr_b32 s14, s2, 1
    s_lshl_b32 s14, s14, 6
    s_add_u32 s14, s14, s13
    s_lshl_b32 s13, s3, 2
    s_add_u32 s14, s14, s13
    v_and_b32 v173, 7, v0
    v_lshl_add_u32 v173, v76, 3, v173
    v_lshl_add_u32 v173, v173, 1, s14
    v_or_b32 v202, v4, v5
    v_mov_b32 v203, 0x0c0c0c0c
    s_bitcmp1_b32 s3, 0
    s_cselect_b32 s12, 0x02020202, 0
    s_xor_b32 s13, s12, 0x03020302
    s_xor_b32 s12, s12, 0x01000100
    s_xor_b32 s76, s3, 0
    s_lshl_b32 s76, s76, 13
    s_xor_b32 s77, s3, 1
    s_lshl_b32 s77, s77, 13
    s_xor_b32 s78, s3, 2
    s_lshl_b32 s78, s78, 13
    s_xor_b32 s79, s3, 3
    s_lshl_b32 s79, s79, 13
    v_bfi_b32 v204, v202, s12, v203
    v_bfi_b32 v205, v202, s13, v203
    s_waitcnt vmcnt(5)
    buffer_load_dwordx4 v[112:115], v1, s[20:23], s52 offen offset:1280 nt
    v_mfma_f32_16x16x32_bf16 v[48:51], v[88:91], v[28:31], 0
    v_add_f32_dpp v17, v45, v44 quad_perm:[1,0,3,2] row_mask:0xf bank_mask:0xf
    v_add_f32_dpp v18, v47, v46 quad_perm:[1,0,3,2] row_mask:0xf bank_mask:0xf
    s_nop 1
    v_add_f32_dpp v6, v18, v17 quad_perm:[2,3,0,1] row_mask:0xf bank_mask:0xf
    v_bfe_u32 v202, v0, 1, 2
    v_cmp_eq_u32 vcc, 0, v202
    s_nop 1
    v_cndmask_b32 v156, v203, v204, vcc
    v_cndmask_b32 v160, v203, v205, vcc
    v_cmp_eq_u32 vcc, 1, v202
    s_nop 1
    v_cndmask_b32 v157, v203, v204, vcc
    v_cndmask_b32 v161, v203, v205, vcc
    v_cmp_eq_u32 vcc, 2, v202
    s_nop 1
    v_cndmask_b32 v158, v203, v204, vcc
    v_cndmask_b32 v162, v203, v205, vcc
    v_cmp_eq_u32 vcc, 3, v202
    s_nop 1
    v_cndmask_b32 v159, v203, v204, vcc
    v_cndmask_b32 v163, v203, v205, vcc
    s_mov_b32 s9, 0x2000
    s_mov_b32 s10, 0x4000
    s_mov_b32 s11, 0x6000
    s_mov_b32 s12, 0x8000
    s_mov_b32 s13, 0xa000
    s_mov_b32 s14, 0xc000
L_pad19:
    s_cbranch_execz L_pad20
    s_mov_b32 s15, 0xe000
    s_mov_b32 s59, 1
    s_mov_b32 s53, 1
    s_mov_b32 s73, 0x200000
    s_branch L_kloop
L_epi:
    s_lshl_b32 s4, s59, 2
    s_add_u32 s4, s4, s3
    s_lshl_b32 s5, s4, 11
    v_add_u32 v79, s5, v3
    s_cmp_lg_u32 s67, 0
    s_cbranch_scc0 L_lda_slow
    buffer_load_dwordx4 v[148:151], v171, s[36:39], 0 offen nt
    buffer_load_dwordx4 v[152:155], v171, s[36:39], 0 offen offset:1024 nt
L_lda_back:
    s_waitcnt vmcnt(7)
    buffer_load_dwordx4 v[116:119], v168, s[32:35], s76 offen nt
    v_mfma_f32_16x16x32_bf16 v[36:39], v[92:95], v[62:65], v[36:39]
    v_mfma_f32_16x16x32_bf16 v[40:43], v[92:95], v[60:63], v[40:43]
    v_and_b32_dpp v66, v21, v4 quad_perm:[3,3,3,3] row_mask:0xf bank_mask:0xf
    v_and_b32_dpp v67, v21, v5 quad_perm:[3,3,3,3] row_mask:0xf bank_mask:0xf
    v_mov_b32 v166, v164
    s_nop 1
    v_max_f32_dpp v166, v166, v166 quad_perm:[1,0,3,2] row_mask:0xf bank_mask:0xf
    s_nop 1
    v_max_f32_dpp v166, v166, v166 quad_perm:[2,3,0,1] row_mask:0xf bank_mask:0xf
    v_mov_b32 v167, v166
    s_nop 1
    v_permlane16_swap_b32 v167, v166
    v_max_f32 v166, v166, v167
    v_mov_b32 v167, v166
    s_nop 1
    v_permlane32_swap_b32 v167, v166
    v_max_f32 v166, v166, v167
    s_waitcnt vmcnt(7)
    buffer_load_dwordx4 v[120:123], v168, s[32:35], s77 offen nt
    v_mfma_f32_16x16x32_bf16 v[36:39], v[96:99], v[66:69], v[36:39]
    v_mfma_f32_16x16x32_bf16 v[40:43], v[96:99], v[64:67], v[40:43]
    v_fma_f32 v20, v9, s55, -v13
    v_exp_f32 v20, v20
    s_nop 0
    v_cvt_pk_bf16_f32 v21, v20, v20
    s_nop 1
    v_and_b32_dpp v54, v21, v4 quad_perm:[0,0,0,0] row_mask:0xf bank_mask:0xf
    v_and_b32_dpp v55, v21, v5 quad_perm:[0,0,0,0] row_mask:0xf bank_mask:0xf
    v_and_b32_dpp v58, v21, v4 quad_perm:[1,1,1,1] row_mask:0xf bank_mask:0xf
    v_and_b32_dpp v59, v21, v5 quad_perm:[1,1,1,1] row_mask:0xf bank_mask:0xf
    v_and_b32_dpp v62, v21, v4 quad_perm:[2,2,2,2] row_mask:0xf bank_mask:0xf
    v_and_b32_dpp v63, v21, v5 quad_perm:[2,2,2,2] row_mask:0xf bank_mask:0xf
    v_and_b32_dpp v66, v21, v4 quad_perm:[3,3,3,3] row_mask:0xf bank_mask:0xf
    v_and_b32_dpp v67, v21, v5 quad_perm:[3,3,3,3] row_mask:0xf bank_mask:0xf
    v_mul_f32 v166, s55, v166
    v_fma_f32 v164, v164, s55, -v166
    s_waitcnt lgkmcnt(0)
    v_fma_f32 v176, v44, s55, -v166
    v_fma_f32 v177, v46, s55, -v166
    v_fma_f32 v178, v48, s55, -v166
    v_fma_f32 v179, v50, s55, -v166
    v_exp_f32 v164, v164
    v_exp_f32 v176, v176
    s_waitcnt vmcnt(7)
    buffer_load_dwordx4 v[124:127], v168, s[32:35], s78 offen nt
    v_mfma_f32_16x16x32_bf16 v[36:39], v[100:103], v[54:57], v[36:39]
    v_mfma_f32_16x16x32_bf16 v[40:43], v[100:103], v[52:55], v[40:43]
    v_exp_f32 v177, v177
    v_exp_f32 v178, v178
    v_exp_f32 v179, v179
    v_mul_f32 v165, v165, v164
    s_nop 1
    v_add_f32_dpp v165, v165, v165 quad_perm:[1,0,3,2] row_mask:0xf bank_mask:0xf
    s_nop 1
    v_add_f32_dpp v165, v165, v165 quad_perm:[2,3,0,1] row_mask:0xf bank_mask:0xf
    v_mov_b32 v167, v165
    s_nop 1
    v_permlane16_swap_b32 v167, v165
    v_add_f32 v165, v165, v167
    s_waitcnt vmcnt(7)
    buffer_load_dwordx4 v[128:131], v168, s[32:35], s79 offen nt
    v_mfma_f32_16x16x32_bf16 v[36:39], v[104:107], v[58:61], v[36:39]
    v_mfma_f32_16x16x32_bf16 v[40:43], v[104:107], v[56:59], v[40:43]
    v_mov_b32 v167, v165
    s_nop 1
    v_permlane32_swap_b32 v167, v165
    v_add_f32 v165, v165, v167
    v_rcp_f32 v165, v165
    s_nop 0
    v_mul_f32 v165, v165, v175
    v_mul_f32 v176, v176, v165
    v_mul_f32 v177, v177, v165
    v_mul_f32 v178, v178, v165
    v_mul_f32 v179, v179, v165
    s_waitcnt vmcnt(7)
    buffer_load_dwordx4 v[132:135], v168, s[28:31], s76 offen nt
    v_mfma_f32_16x16x32_bf16 v[36:39], v[108:111], v[62:65], v[36:39]
    v_mfma_f32_16x16x32_bf16 v[40:43], v[108:111], v[60:63], v[40:43]
    s_waitcnt vmcnt(7)
    buffer_load_dwordx4 v[136:139], v168, s[28:31], s77 offen nt
    v_mfma_f32_16x16x32_bf16 v[36:39], v[112:115], v[66:69], v[36:39]
L_pad20:
    s_cbranch_execz L_pad21
    v_mfma_f32_16x16x32_bf16 v[40:43], v[112:115], v[64:67], v[40:43]
    buffer_load_dwordx4 v[140:143], v168, s[28:31], s78 offen nt
    buffer_load_dwordx4 v[144:147], v168, s[28:31], s79 offen nt
    s_nop 4
    ds_write_b128 v79, v[36:39] offset:32768
    ds_write_b128 v79, v[40:43] offset:33792
    s_cmp_ge_u32 s3, 2
    s_waitcnt lgkmcnt(0)
    s_barrier
    s_cbranch_scc1 L_bfirst
    ds_read_b128 v[202:205], v169 offset:40960
    ds_read_b128 v[206:209], v169 offset:43008
    ds_read_b128 v[210:213], v169 offset:45056
    ds_read_b128 v[214:217], v169 offset:47104
    s_cmp_lg_u32 s67, 0
    s_waitcnt lgkmcnt(3)
    v_mul_f32 v202, v202, v176
    v_mul_f32 v203, v203, v176
    v_mul_f32 v204, v204, v176
    v_mul_f32 v205, v205, v176
    s_waitcnt lgkmcnt(2)
    v_fmac_f32 v202, v206, v177
    v_fmac_f32 v203, v207, v177
    v_fmac_f32 v204, v208, v177
    v_fmac_f32 v205, v209, v177
    s_waitcnt lgkmcnt(1)
    v_fmac_f32 v202, v210, v178
    v_fmac_f32 v203, v211, v178
    v_fmac_f32 v204, v212, v178
    v_fmac_f32 v205, v213, v178
    s_waitcnt lgkmcnt(0)
    v_fmac_f32 v202, v214, v179
    v_fmac_f32 v203, v215, v179
    v_fmac_f32 v204, v216, v179
    v_fmac_f32 v205, v217, v179
    v_and_or_b32 v202, v202, v27, s68
    v_and_or_b32 v203, v203, v27, s69
    v_and_or_b32 v204, v204, v27, s70
    v_and_or_b32 v205, v205, v27, s71
    s_cbranch_scc0 L_oslow
    buffer_store_dwordx4 v[202:205], v170, s[36:39], s17 offen
L_bfirst:
L_bmfa:
    s_waitcnt vmcnt(8)
L_oachk:
    v_xor_b32 v148, s68, v148
    v_xor_b32 v149, s69, v149
    v_xor_b32 v150, s70, v150
    v_xor_b32 v151, s71, v151
    v_or_b32 v81, v148, v149
    v_or3_b32 v81, v150, v151, v81
    v_xor_b32 v152, s68, v152
    v_xor_b32 v153, s69, v153
    v_xor_b32 v154, s70, v154
    v_xor_b32 v155, s71, v155
    v_or3_b32 v81, v152, v153, v81
    v_or3_b32 v81, v154, v155, v81
    v_and_b32 v81, 0xff, v81
    v_cmp_ne_u32 vcc, 0, v81
    s_cbranch_vccnz L_oaretry
    v_add_f32 v148, v148, v152
    v_add_f32 v149, v149, v153
    v_add_f32 v150, v150, v154
    v_add_f32 v151, v151, v155
    s_nop 0
    v_permlane16_swap_b32 v148, v150
    v_permlane16_swap_b32 v149, v151
    v_add_f32 v148, v148, v150
    v_add_f32 v149, v149, v151
    s_nop 0
    v_add_f32_dpp v148, v148, v148 row_ror:4 row_mask:0xf bank_mask:0xf
    v_add_f32_dpp v149, v149, v149 row_ror:4 row_mask:0xf bank_mask:0xf
    s_nop 0
    v_add_f32_dpp v148, v148, v148 row_ror:8 row_mask:0xf bank_mask:0xf
    v_add_f32_dpp v149, v149, v149 row_ror:8 row_mask:0xf bank_mask:0xf
    v_cvt_pk_bf16_f32 v150, v148, v149
    ds_bpermute_b32 v148, v200, v150
    ds_bpermute_b32 v149, v201, v150
    s_waitcnt lgkmcnt(0)
    v_perm_b32 v180, v148, v148, v156
    v_perm_b32 v181, v148, v148, v157
    v_perm_b32 v182, v148, v148, v158
    v_perm_b32 v183, v148, v148, v159
    v_perm_b32 v184, v148, v148, v160
    v_perm_b32 v185, v148, v148, v161
    v_perm_b32 v186, v148, v148, v162
    v_perm_b32 v187, v148, v148, v163
    v_perm_b32 v188, v149, v149, v156
    v_perm_b32 v189, v149, v149, v157
    v_perm_b32 v190, v149, v149, v158
    v_perm_b32 v191, v149, v149, v159
    v_perm_b32 v192, v149, v149, v160
    v_perm_b32 v193, v149, v149, v161
    v_perm_b32 v194, v149, v149, v162
    v_perm_b32 v195, v149, v149, v163
    s_cmp_lg_u32 s67, 0
    s_cbranch_scc0 L_bp_slow
    buffer_load_dwordx4 v[218:221], v171, s[36:39], s17 offen nt
    buffer_load_dwordx4 v[222:225], v171, s[36:39], s17 offen offset:1024 nt
L_bp_back:
L_pad21:
    s_cbranch_execz L_pad22
    s_waitcnt vmcnt(6)
    v_mfma_f32_16x16x32_bf16 v[44:47], v[116:119], v[180:183], 0
    v_mfma_f32_16x16x32_bf16 v[44:47], v[120:123], v[184:187], v[44:47]
    v_mfma_f32_16x16x32_bf16 v[44:47], v[124:127], v[188:191], v[44:47]
    v_mfma_f32_16x16x32_bf16 v[44:47], v[128:131], v[192:195], v[44:47]
L_bchk:
    s_waitcnt vmcnt(1)
    v_xor_b32 v218, s68, v218
    v_xor_b32 v219, s69, v219
    v_xor_b32 v220, s70, v220
    v_xor_b32 v221, s71, v221
    v_or_b32 v81, v218, v219
    v_or3_b32 v81, v220, v221, v81
    s_waitcnt vmcnt(0)
    v_xor_b32 v222, s68, v222
    v_xor_b32 v223, s69, v223
    v_xor_b32 v224, s70, v224
    v_xor_b32 v225, s71, v225
    v_or3_b32 v81, v222, v223, v81
    v_or3_b32 v81, v224, v225, v81
    v_and_b32 v81, 0xff, v81
    v_cmp_ne_u32 vcc, 0, v81
    s_cbranch_vccnz L_bretry
    s_mov_b64 exec, -1
    v_add_f32 v218, v218, v222
    v_add_f32 v219, v219, v223
    v_add_f32 v220, v220, v224
    v_add_f32 v221, v221, v225
    s_nop 0
    v_permlane16_swap_b32 v218, v220
    v_permlane16_swap_b32 v219, v221
    v_add_f32 v218, v218, v220
    v_add_f32 v219, v219, v221
    s_nop 0
    v_add_f32_dpp v218, v218, v218 row_ror:4 row_mask:0xf bank_mask:0xf
    v_add_f32_dpp v219, v219, v219 row_ror:4 row_mask:0xf bank_mask:0xf
    s_nop 0
    v_add_f32_dpp v218, v218, v218 row_ror:8 row_mask:0xf bank_mask:0xf
    v_add_f32_dpp v219, v219, v219 row_ror:8 row_mask:0xf bank_mask:0xf
    v_cvt_pk_bf16_f32 v220, v218, v219
    ds_bpermute_b32 v218, v200, v220
    ds_bpermute_b32 v219, v201, v220
    s_waitcnt lgkmcnt(0)
    v_perm_b32 v226, v218, v218, v156
    v_perm_b32 v227, v218, v218, v157
    v_perm_b32 v228, v218, v218, v158
    v_perm_b32 v229, v218, v218, v159
    v_perm_b32 v230, v218, v218, v160
    v_perm_b32 v231, v218, v218, v161
    v_perm_b32 v232, v218, v218, v162
    v_perm_b32 v233, v218, v218, v163
    v_mfma_f32_16x16x32_bf16 v[44:47], v[132:135], v[226:229], v[44:47]
    v_perm_b32 v234, v219, v219, v156
    v_perm_b32 v235, v219, v219, v157
    v_perm_b32 v236, v219, v219, v158
    v_perm_b32 v237, v219, v219, v159
    v_mfma_f32_16x16x32_bf16 v[44:47], v[136:139], v[230:233], v[44:47]
    v_perm_b32 v238, v219, v219, v160
    v_perm_b32 v239, v219, v219, v161
    v_perm_b32 v240, v219, v219, v162
    v_perm_b32 v241, v219, v219, v163
    v_mfma_f32_16x16x32_bf16 v[44:47], v[140:143], v[234:237], v[44:47]
    s_nop 0
    v_mfma_f32_16x16x32_bf16 v[44:47], v[144:147], v[238:241], v[44:47]
    s_cmp_lg_u32 s3, 0
    s_nop 6
    ds_write_b128 v169, v[44:47] offset:53248
    s_waitcnt lgkmcnt(0)
    s_barrier
    s_cbranch_scc1 L_cother
    ds_read_b128 v[206:209], v3 offset:54272
    ds_read_b128 v[210:213], v3 offset:55296
    ds_read_b128 v[214:217], v3 offset:56320
    s_cmp_ge_u32 s2, 32
    s_waitcnt lgkmcnt(0)
    v_add_f32 v206, v206, v44
    v_add_f32 v207, v207, v45
    v_add_f32 v208, v208, v46
    v_add_f32 v209, v209, v47
    v_add_f32 v210, v210, v214
    v_add_f32 v211, v211, v215
    v_add_f32 v212, v212, v216
    v_add_f32 v213, v213, v217
    v_add_f32 v206, v206, v210
    v_add_f32 v207, v207, v211
    v_add_f32 v208, v208, v212
    v_add_f32 v209, v209, v213
    v_and_or_b32 v206, v206, v27, s68
    v_and_or_b32 v207, v207, v27, s69
    v_and_or_b32 v208, v208, v27, s70
    v_and_or_b32 v209, v209, v27, s71
    buffer_store_dwordx4 v[206:209], v3, s[36:39], s16 offen sc1
    s_cbranch_scc1 L_fin
    s_waitcnt vmcnt(0)
L_cbar:
    s_mov_b32 s4, 0x30003
    s_mov_b32 s5, 0x30003
    s_barrier
L_cpoll:
L_pad22:
    s_cbranch_execz L_pad23
    buffer_load_dwordx4 v[210:213], v172, s[36:39], 0 offen sc1
    buffer_load_dwordx4 v[214:217], v172, s[36:39], s12 offen sc1
    s_waitcnt vmcnt(1)
    v_xor_b32 v210, s68, v210
    v_xor_b32 v211, s69, v211
    v_xor_b32 v212, s70, v212
    v_xor_b32 v213, s71, v213
    v_or_b32 v81, v210, v211
    v_or3_b32 v81, v212, v213, v81
    s_waitcnt vmcnt(0)
    v_xor_b32 v214, s68, v214
    v_xor_b32 v215, s69, v215
    v_xor_b32 v216, s70, v216
    v_xor_b32 v217, s71, v217
    v_or3_b32 v81, v214, v215, v81
    v_or3_b32 v81, v216, v217, v81
    v_and_b32 v81, 0xff, v81
    v_cmp_ne_u32 vcc, 0, v81
    s_cbranch_vccnz L_cretry
    s_mov_b64 exec, -1
    v_add_f32 v210, v210, v214
    v_add_f32 v211, v211, v215
    v_add_f32 v212, v212, v216
    v_add_f32 v213, v213, v217
    s_nop 0
    v_permlane32_swap_b32 v210, v212
    v_permlane32_swap_b32 v211, v213
    v_add_f32 v210, v210, v212
    v_add_f32 v211, v211, v213
    s_nop 1
    v_permlane16_swap_b32 v210, v211
    v_add_f32 v210, v210, v211
    s_nop 1
    v_add_f32_dpp v210, v210, v210 row_ror:8 row_mask:0xf bank_mask:0xf
    s_nop 1
    v_add_f32_dpp v210, v210, v210 row_ror:4 row_mask:0xf bank_mask:0xf
    s_nop 1
    v_add_f32_dpp v210, v210, v210 quad_perm:[2,3,0,1] row_mask:0xf bank_mask:0xf
    v_cvt_pk_bf16_f32 v210, v210, v210
    s_mov_b64 exec, s[4:5]
    buffer_store_short v210, v173, s[48:51], 0 offen
    s_or_b32 s4, s2, s3
    s_cbranch_scc1 L_fin
    s_mov_b64 exec, 1
    v_mov_b32 v211, s54
    buffer_store_dword v211, v0, s[36:39], 0 offen
L_fin:
L_end:
    s_endpgm
L_bretry:
    s_sub_u32 s58, s58, 1
    s_cbranch_scc1 L_end
    s_mov_b64 exec, vcc
    s_cmp_lg_u32 s67, 0
    s_cbranch_scc0 L_bretry_slow
    buffer_load_dwordx4 v[218:221], v171, s[36:39], s17 offen nt
    buffer_load_dwordx4 v[222:225], v171, s[36:39], s17 offen offset:1024 nt
    s_branch L_bchk
L_cother:
    s_cmp_ge_u32 s2, 32
    s_cbranch_scc0 L_cbar
    s_branch L_fin
L_cretry:
    s_sub_u32 s58, s58, 1
    s_cbranch_scc1 L_end
    s_mov_b64 exec, vcc
    s_branch L_cpoll
L_bsel:
    s_cmp_lg_u32 s67, 0
    s_cbranch_scc1 L_bfirst
    s_branch L_bslow
L_oslow:
    buffer_store_dwordx4 v[202:205], v170, s[36:39], s17 offen sc1
L_bslow:
    s_branch L_bmfa
L_bp_slow:
    buffer_load_dwordx4 v[218:221], v171, s[36:39], s17 offen sc1
    buffer_load_dwordx4 v[222:225], v171, s[36:39], s17 offen offset:1024 sc1
    s_branch L_bp_back
L_bretry_slow:
    buffer_load_dwordx4 v[218:221], v171, s[36:39], s17 offen sc1
    buffer_load_dwordx4 v[222:225], v171, s[36:39], s17 offen offset:1024 sc1
    s_branch L_bchk
L_side:
    s_lshr_b32 s5, s2, 7
    s_lshl_b32 s5, s5, 10
    s_cmp_lg_u32 s59, 0
    s_cbranch_scc0 L_side0
    buffer_load_dwordx4 v[148:151], v3, s[40:43], s5 offen
    s_cmp_lg_u32 s67, 0
    s_cbranch_scc0 L_sta_slow
    buffer_store_dwordx4 v[196:199], v170, s[36:39], 0 offen
L_sta_back:
    s_branch L_side4
L_side0:
    buffer_load_dwordx4 v[148:151], v3, s[40:43], s5 offen
    buffer_load_dwordx4 v[152:155], v3, s[44:47], 0 offen
L_side4:
    s_cmp_lg_u32 s67, 0
    s_cbranch_scc1 L_side1
    buffer_load_dwordx4 v[164:167], v26, s[36:39], 0 offen sc1
    s_branch L_sidebody
L_side1:
    buffer_load_dwordx4 v[164:167], v26, s[36:39], 0 offen nt
L_sidebody:
    s_waitcnt vmcnt(9)
    buffer_load_dwordx4 v[84:87], v2, s[24:27], s73 offen nt
    v_mfma_f32_16x16x32_bf16 v[36:39], v[92:95], v[62:65], v[36:39]
    v_mfma_f32_16x16x32_bf16 v[40:43], v[92:95], v[60:63], v[40:43]
    v_and_b32_dpp v66, v21, v4 quad_perm:[3,3,3,3] row_mask:0xf bank_mask:0xf
    v_and_b32_dpp v67, v21, v5 quad_perm:[3,3,3,3] row_mask:0xf bank_mask:0xf
    s_waitcnt vmcnt(9)
L_pad23:
    s_cbranch_execz L_pad24
    buffer_load_dwordx4 v[88:91], v2, s[24:27], s73 offen offset:256 nt
    v_mfma_f32_16x16x32_bf16 v[36:39], v[96:99], v[66:69], v[36:39]
    v_mfma_f32_16x16x32_bf16 v[40:43], v[96:99], v[64:67], v[40:43]
    v_fma_f32 v20, v9, s55, -v13
    v_exp_f32 v20, v20
    v_add_u32 v12, 512, v12
    ds_read_b64 v[8:9], v12
    v_cvt_pk_bf16_f32 v21, v20, v20
    s_nop 1
    v_and_b32_dpp v54, v21, v4 quad_perm:[0,0,0,0] row_mask:0xf bank_mask:0xf
    v_and_b32_dpp v55, v21, v5 quad_perm:[0,0,0,0] row_mask:0xf bank_mask:0xf
    s_waitcnt vmcnt(9)
    buffer_load_dwordx4 v[92:95], v2, s[24:27], s73 offen offset:1024 nt
    v_mfma_f32_16x16x32_bf16 v[36:39], v[100:103], v[54:57], v[36:39]
    v_mfma_f32_16x16x32_bf16 v[40:43], v[100:103], v[52:55], v[40:43]
    v_and_b32_dpp v58, v21, v4 quad_perm:[1,1,1,1] row_mask:0xf bank_mask:0xf
    v_and_b32_dpp v59, v21, v5 quad_perm:[1,1,1,1] row_mask:0xf bank_mask:0xf
    s_waitcnt vmcnt(9)
    buffer_load_dwordx4 v[96:99], v2, s[24:27], s73 offen offset:1280 nt
    v_mfma_f32_16x16x32_bf16 v[36:39], v[104:107], v[58:61], v[36:39]
    v_mfma_f32_16x16x32_bf16 v[40:43], v[104:107], v[56:59], v[40:43]
    v_and_b32_dpp v62, v21, v4 quad_perm:[2,2,2,2] row_mask:0xf bank_mask:0xf
    v_and_b32_dpp v63, v21, v5 quad_perm:[2,2,2,2] row_mask:0xf bank_mask:0xf
    s_xor_b32 s52, s73, 0x400000
    s_waitcnt vmcnt(9)
    buffer_load_dwordx4 v[100:103], v2, s[24:27], s52 offen nt
    v_mfma_f32_16x16x32_bf16 v[36:39], v[108:111], v[62:65], v[36:39]
    v_mfma_f32_16x16x32_bf16 v[40:43], v[108:111], v[60:63], v[40:43]
    v_and_b32_dpp v66, v21, v4 quad_perm:[3,3,3,3] row_mask:0xf bank_mask:0xf
    v_and_b32_dpp v67, v21, v5 quad_perm:[3,3,3,3] row_mask:0xf bank_mask:0xf
    s_waitcnt vmcnt(4)
    buffer_load_dwordx4 v[104:107], v2, s[24:27], s52 offen offset:256 nt
    v_mfma_f32_16x16x32_bf16 v[36:39], v[112:115], v[66:69], v[36:39]
    v_mfma_f32_16x16x32_bf16 v[40:43], v[112:115], v[64:67], v[40:43]
    s_waitcnt lgkmcnt(0)
    v_fma_f32 v20, v8, s55, -v13
    v_exp_f32 v20, v20
    s_nop 0
    v_cvt_pk_bf16_f32 v21, v20, v20
    s_nop 1
    v_and_b32_dpp v54, v21, v4 quad_perm:[0,0,0,0] row_mask:0xf bank_mask:0xf
    v_and_b32_dpp v55, v21, v5 quad_perm:[0,0,0,0] row_mask:0xf bank_mask:0xf
    s_waitcnt vmcnt(4)
    buffer_load_dwordx4 v[108:111], v2, s[24:27], s52 offen offset:1024 nt
    v_mfma_f32_16x16x32_bf16 v[36:39], v[84:87], v[54:57], v[36:39]
    v_mfma_f32_16x16x32_bf16 v[40:43], v[84:87], v[52:55], v[40:43]
    v_and_b32_dpp v58, v21, v4 quad_perm:[1,1,1,1] row_mask:0xf bank_mask:0xf
    v_and_b32_dpp v59, v21, v5 quad_perm:[1,1,1,1] row_mask:0xf bank_mask:0xf
    s_waitcnt vmcnt(4)
    buffer_load_dwordx4 v[112:115], v2, s[24:27], s52 offen offset:1280 nt
    s_add_u32 s53, s53, 1
    s_and_b32 s73, s53, 1
    s_lshl_b32 s73, s73, 21
    s_and_b32 s4, s53, 6
    s_lshl_b32 s4, s4, 18
    s_add_u32 s73, s73, s4
    s_and_b32 s4, s53, 8
    s_lshl_b32 s4, s4, 14
    s_add_u32 s73, s73, s4
    v_mfma_f32_16x16x32_bf16 v[36:39], v[88:91], v[58:61], v[36:39]
    v_mfma_f32_16x16x32_bf16 v[40:43], v[88:91], v[56:59], v[40:43]
    v_and_b32_dpp v62, v21, v4 quad_perm:[2,2,2,2] row_mask:0xf bank_mask:0xf
    v_and_b32_dpp v63, v21, v5 quad_perm:[2,2,2,2] row_mask:0xf bank_mask:0xf
    s_branch L_vloop
L_mlretry:
    s_sub_u32 s58, s58, 1
    s_cbranch_scc1 L_end
    s_cmp_lg_u32 s67, 0
    s_cbranch_scc0 L_mlretry_slow
    buffer_load_dwordx4 v[164:167], v26, s[36:39], 0 offen nt
    s_waitcnt vmcnt(0)
    s_branch L_mlchk
L_mlretry_slow:
    buffer_load_dwordx4 v[164:167], v26, s[36:39], 0 offen sc1
    s_waitcnt vmcnt(0)
    s_branch L_mlchk
L_oaretry:
    s_sub_u32 s58, s58, 1
    s_cbranch_scc1 L_end
    s_cmp_lg_u32 s67, 0
    s_cbranch_scc0 L_oaretry_slow
    buffer_load_dwordx4 v[148:151], v171, s[36:39], 0 offen nt
    buffer_load_dwordx4 v[152:155], v171, s[36:39], 0 offen offset:1024 nt
    s_waitcnt vmcnt(0)
    s_branch L_oachk
L_oaretry_slow:
    buffer_load_dwordx4 v[148:151], v171, s[36:39], 0 offen sc1
    buffer_load_dwordx4 v[152:155], v171, s[36:39], 0 offen offset:1024 sc1
    s_waitcnt vmcnt(0)
    s_branch L_oachk
L_kturbo:
    buffer_load_dwordx4 v[84:87], v1, s[20:23], s73 offen nt
    buffer_load_dwordx4 v[88:91], v1, s[20:23], s73 offen offset:256 nt
    s_waitcnt vmcnt(9)
    v_mfma_f32_16x16x32_bf16 v[44:47], v[92:95], v[28:31], 0
    buffer_load_dwordx4 v[92:95], v1, s[20:23], s73 offen offset:1024 nt
    v_add_f32_dpp v17, v48, v49 quad_perm:[1,0,3,2] row_mask:0xf bank_mask:0xf
    v_add_f32_dpp v18, v50, v51 quad_perm:[1,0,3,2] row_mask:0xf bank_mask:0xf
    s_nop 1
    v_add_f32_dpp v19, v18, v17 quad_perm:[2,3,0,1] row_mask:0xf bank_mask:0xf
    v_cndmask_b32 v6, v6, v19, s[60:61]
L_pad24:
    s_cbranch_execz L_pad25
    s_waitcnt vmcnt(9)
    v_mfma_f32_16x16x32_bf16 v[48:51], v[96:99], v[28:31], 0
    buffer_load_dwordx4 v[96:99], v1, s[20:23], s73 offen offset:1280 nt
    v_add_f32_dpp v17, v47, v46 quad_perm:[1,0,3,2] row_mask:0xf bank_mask:0xf
    v_add_f32_dpp v18, v45, v44 quad_perm:[1,0,3,2] row_mask:0xf bank_mask:0xf
    s_nop 1
    v_add_f32_dpp v19, v18, v17 quad_perm:[2,3,0,1] row_mask:0xf bank_mask:0xf
    v_cndmask_b32 v6, v6, v19, s[62:63]
    s_waitcnt vmcnt(9)
    v_mfma_f32_16x16x32_bf16 v[44:47], v[100:103], v[28:31], 0
    s_xor_b32 s52, s73, 0x400000
    buffer_load_dwordx4 v[100:103], v1, s[20:23], s52 offen nt
    v_add_f32_dpp v17, v50, v51 quad_perm:[1,0,3,2] row_mask:0xf bank_mask:0xf
    v_add_f32_dpp v18, v48, v49 quad_perm:[1,0,3,2] row_mask:0xf bank_mask:0xf
    s_nop 1
    v_add_f32_dpp v19, v18, v17 quad_perm:[2,3,0,1] row_mask:0xf bank_mask:0xf
    v_cndmask_b32 v6, v6, v19, s[64:65]
    v_cvt_pk_bf16_f32 v6, 0, v6
    v_mul_f32 v6, 0x3db504f3, v6
    v_cvt_pk_bf16_f32 v6, 0, v6
    s_waitcnt vmcnt(9)
    v_mfma_f32_16x16x32_bf16 v[48:51], v[104:107], v[28:31], 0
    buffer_load_dwordx4 v[104:107], v1, s[20:23], s52 offen offset:256 nt
    v_add_f32_dpp v17, v45, v44 quad_perm:[1,0,3,2] row_mask:0xf bank_mask:0xf
    v_add_f32_dpp v18, v47, v46 quad_perm:[1,0,3,2] row_mask:0xf bank_mask:0xf
    s_nop 1
    v_add_f32_dpp v7, v18, v17 quad_perm:[2,3,0,1] row_mask:0xf bank_mask:0xf
    s_waitcnt vmcnt(9)
    v_mfma_f32_16x16x32_bf16 v[44:47], v[108:111], v[28:31], 0
    buffer_load_dwordx4 v[108:111], v1, s[20:23], s52 offen offset:1024 nt
    v_add_f32_dpp v17, v48, v49 quad_perm:[1,0,3,2] row_mask:0xf bank_mask:0xf
    v_add_f32_dpp v18, v50, v51 quad_perm:[1,0,3,2] row_mask:0xf bank_mask:0xf
    s_nop 1
    v_add_f32_dpp v19, v18, v17 quad_perm:[2,3,0,1] row_mask:0xf bank_mask:0xf
    v_cndmask_b32 v7, v7, v19, s[60:61]
    s_waitcnt vmcnt(9)
    v_mfma_f32_16x16x32_bf16 v[48:51], v[112:115], v[28:31], 0
    buffer_load_dwordx4 v[112:115], v1, s[20:23], s52 offen offset:1280 nt
    v_add_f32_dpp v17, v47, v46 quad_perm:[1,0,3,2] row_mask:0xf bank_mask:0xf
    v_add_f32_dpp v18, v45, v44 quad_perm:[1,0,3,2] row_mask:0xf bank_mask:0xf
    s_nop 1
    v_add_f32_dpp v19, v18, v17 quad_perm:[2,3,0,1] row_mask:0xf bank_mask:0xf
    v_cndmask_b32 v7, v7, v19, s[62:63]
    s_waitcnt vmcnt(7)
    v_mfma_f32_16x16x32_bf16 v[44:47], v[84:87], v[28:31], 0
    v_add_f32_dpp v17, v50, v51 quad_perm:[1,0,3,2] row_mask:0xf bank_mask:0xf
    v_add_f32_dpp v18, v48, v49 quad_perm:[1,0,3,2] row_mask:0xf bank_mask:0xf
    s_nop 1
    v_add_f32_dpp v19, v18, v17 quad_perm:[2,3,0,1] row_mask:0xf bank_mask:0xf
    v_cndmask_b32 v7, v7, v19, s[64:65]
    v_cvt_pk_bf16_f32 v7, 0, v7
    v_mul_f32 v7, 0x3db504f3, v7
    v_cvt_pk_bf16_f32 v7, 0, v7
    v_mul_f32 v16, s55, v10
    v_max3_f32 v10, v6, v7, v10
    ds_write_b64 v12, v[6:7]
    v_mul_f32 v20, s55, v10
    v_add_u32 v12, 512, v12
    v_fma_f32 v14, v6, s55, -v20
    v_fma_f32 v15, v7, s55, -v20
    v_sub_f32 v16, v16, v20
    s_waitcnt vmcnt(6)
    v_mfma_f32_16x16x32_bf16 v[48:51], v[88:91], v[28:31], 0
    v_add_f32_dpp v17, v45, v44 quad_perm:[1,0,3,2] row_mask:0xf bank_mask:0xf
    v_add_f32_dpp v18, v47, v46 quad_perm:[1,0,3,2] row_mask:0xf bank_mask:0xf
    s_nop 1
    v_add_f32_dpp v6, v18, v17 quad_perm:[2,3,0,1] row_mask:0xf bank_mask:0xf
    v_exp_f32 v14, v14
    v_exp_f32 v16, v16
    v_exp_f32 v15, v15
    v_fma_f32 v11, v11, v16, v14
    v_add_f32 v11, v11, v15
    s_add_u32 s53, s53, 1
    s_and_b32 s73, s53, 1
    s_lshl_b32 s73, s73, 21
    s_and_b32 s4, s53, 6
    s_lshl_b32 s4, s4, 18
    s_add_u32 s73, s73, s4
    s_and_b32 s4, s53, 8
    s_lshl_b32 s4, s4, 14
    s_add_u32 s73, s73, s4
    s_cmp_lg_u32 s53, 16
    s_cbranch_scc1 L_kloop
    s_branch L_kdone
L_vturbo:
    buffer_load_dwordx4 v[84:87], v2, s[24:27], s73 offen nt
    buffer_load_dwordx4 v[88:91], v2, s[24:27], s73 offen offset:256 nt
    s_waitcnt vmcnt(9)
    v_mfma_f32_16x16x32_bf16 v[36:39], v[92:95], v[62:65], v[36:39]
    v_mfma_f32_16x16x32_bf16 v[40:43], v[92:95], v[60:63], v[40:43]
    buffer_load_dwordx4 v[92:95], v2, s[24:27], s73 offen offset:1024 nt
    v_and_b32_dpp v66, v21, v4 quad_perm:[3,3,3,3] row_mask:0xf bank_mask:0xf
    v_and_b32_dpp v67, v21, v5 quad_perm:[3,3,3,3] row_mask:0xf bank_mask:0xf
    s_waitcnt vmcnt(9)
    s_nop 0
    v_mfma_f32_16x16x32_bf16 v[36:39], v[96:99], v[66:69], v[36:39]
    v_mfma_f32_16x16x32_bf16 v[40:43], v[96:99], v[64:67], v[40:43]
L_pad25:
    s_cbranch_execz L_pad26
    buffer_load_dwordx4 v[96:99], v2, s[24:27], s73 offen offset:1280 nt
    v_fma_f32 v20, v9, s55, -v13
    v_exp_f32 v20, v20
    v_add_u32 v12, 512, v12
    ds_read_b64 v[8:9], v12
    v_cvt_pk_bf16_f32 v21, v20, v20
    s_nop 1
    v_and_b32_dpp v54, v21, v4 quad_perm:[0,0,0,0] row_mask:0xf bank_mask:0xf
    v_and_b32_dpp v55, v21, v5 quad_perm:[0,0,0,0] row_mask:0xf bank_mask:0xf
    s_waitcnt vmcnt(9)
    s_nop 0
    v_mfma_f32_16x16x32_bf16 v[36:39], v[100:103], v[54:57], v[36:39]
    v_mfma_f32_16x16x32_bf16 v[40:43], v[100:103], v[52:55], v[40:43]
    s_xor_b32 s52, s73, 0x400000
    buffer_load_dwordx4 v[100:103], v2, s[24:27], s52 offen nt
    v_and_b32_dpp v58, v21, v4 quad_perm:[1,1,1,1] row_mask:0xf bank_mask:0xf
    v_and_b32_dpp v59, v21, v5 quad_perm:[1,1,1,1] row_mask:0xf bank_mask:0xf
    s_waitcnt vmcnt(9)
    s_nop 0
    v_mfma_f32_16x16x32_bf16 v[36:39], v[104:107], v[58:61], v[36:39]
    v_mfma_f32_16x16x32_bf16 v[40:43], v[104:107], v[56:59], v[40:43]
    buffer_load_dwordx4 v[104:107], v2, s[24:27], s52 offen offset:256 nt
    v_and_b32_dpp v62, v21, v4 quad_perm:[2,2,2,2] row_mask:0xf bank_mask:0xf
    v_and_b32_dpp v63, v21, v5 quad_perm:[2,2,2,2] row_mask:0xf bank_mask:0xf
    s_waitcnt vmcnt(9)
    s_nop 0
    v_mfma_f32_16x16x32_bf16 v[36:39], v[108:111], v[62:65], v[36:39]
    v_mfma_f32_16x16x32_bf16 v[40:43], v[108:111], v[60:63], v[40:43]
    buffer_load_dwordx4 v[108:111], v2, s[24:27], s52 offen offset:1024 nt
    v_and_b32_dpp v66, v21, v4 quad_perm:[3,3,3,3] row_mask:0xf bank_mask:0xf
    v_and_b32_dpp v67, v21, v5 quad_perm:[3,3,3,3] row_mask:0xf bank_mask:0xf
    s_waitcnt vmcnt(9)
    s_nop 0
    v_mfma_f32_16x16x32_bf16 v[36:39], v[112:115], v[66:69], v[36:39]
    v_mfma_f32_16x16x32_bf16 v[40:43], v[112:115], v[64:67], v[40:43]
    buffer_load_dwordx4 v[112:115], v2, s[24:27], s52 offen offset:1280 nt
    s_waitcnt lgkmcnt(0)
    v_fma_f32 v20, v8, s55, -v13
    v_exp_f32 v20, v20
    s_nop 0
    v_cvt_pk_bf16_f32 v21, v20, v20
    s_nop 1
    v_and_b32_dpp v54, v21, v4 quad_perm:[0,0,0,0] row_mask:0xf bank_mask:0xf
    v_and_b32_dpp v55, v21, v5 quad_perm:[0,0,0,0] row_mask:0xf bank_mask:0xf
    s_waitcnt vmcnt(7)
    s_nop 0
    v_mfma_f32_16x16x32_bf16 v[36:39], v[84:87], v[54:57], v[36:39]
    v_mfma_f32_16x16x32_bf16 v[40:43], v[84:87], v[52:55], v[40:43]
    v_and_b32_dpp v58, v21, v4 quad_perm:[1,1,1,1] row_mask:0xf bank_mask:0xf
    v_and_b32_dpp v59, v21, v5 quad_perm:[1,1,1,1] row_mask:0xf bank_mask:0xf
    s_waitcnt vmcnt(6)
    s_nop 0
    v_mfma_f32_16x16x32_bf16 v[36:39], v[88:91], v[58:61], v[36:39]
    v_mfma_f32_16x16x32_bf16 v[40:43], v[88:91], v[56:59], v[40:43]
    v_and_b32_dpp v62, v21, v4 quad_perm:[2,2,2,2] row_mask:0xf bank_mask:0xf
    v_and_b32_dpp v63, v21, v5 quad_perm:[2,2,2,2] row_mask:0xf bank_mask:0xf
    s_add_u32 s53, s53, 1
    s_and_b32 s73, s53, 1
    s_lshl_b32 s73, s73, 21
    s_and_b32 s4, s53, 6
    s_lshl_b32 s4, s4, 18
    s_add_u32 s73, s73, s4
    s_and_b32 s4, s53, 8
    s_lshl_b32 s4, s4, 14
    s_add_u32 s73, s73, s4
    s_cmp_lg_u32 s53, 16
    s_cbranch_scc1 L_vloop
    s_branch L_vdone
L_kctl:
    s_cmp_lg_u32 s5, 0
    s_cbranch_scc1 L_kctl2
    s_lshl_b32 s5, s7, 8
    s_add_u32 s5, s5, 0x50100
    s_mov_b32 s101, 1
    s_atomic_add s101, s[36:37], s5 glc
    s_branch L_kctlb
L_kctl2:
    s_lshl_b32 s5, s54, 12
    s_waitcnt lgkmcnt(0)
    s_sub_u32 s101, s101, s5
    s_cmp_ge_u32 s101, 8
    s_cbranch_scc1 L_kctlb
    s_lshl_b32 s101, s101, 2
    s_lshr_b32 s101, 0xc9754322, s101
    s_and_b32 s101, s101, 15
    s_add_u32 s101, s101, 32
    s_add_u32 s5, s5, 63
    v_cmp_gt_u32 vcc, s101, v0
    v_mov_b32 v78, s5
    v_add_u32 v81, 0x800, v78
    v_cndmask_b32 v78, v81, v78, vcc
    s_mov_b32 exec_lo, 0
    buffer_store_dword v78, v23, s[36:39], 0 offen
    s_mov_b32 exec_lo, -1
    s_branch L_kctlb
L_vctl:
    s_cmp_lg_u32 s5, 0
    s_cbranch_scc1 L_vctl2
    s_lshl_b32 s5, s7, 8
L_pad26:
    s_cbranch_execz L_pad27
    s_add_u32 s5, s5, 0x50100
    s_mov_b32 s101, 1
    s_atomic_add s101, s[36:37], s5 glc
    s_branch L_vctlb
L_vctl2:
    s_lshl_b32 s5, s54, 12
    s_waitcnt lgkmcnt(0)
    s_sub_u32 s101, s101, s5
    s_cmp_ge_u32 s101, 8
    s_cbranch_scc1 L_vctlb
    s_lshl_b32 s101, s101, 2
    s_lshr_b32 s101, 0xc9754322, s101
    s_and_b32 s101, s101, 15
    s_add_u32 s101, s101, 32
    s_add_u32 s5, s5, 63
    v_cmp_gt_u32 vcc, s101, v0
    v_mov_b32 v78, s5
    v_add_u32 v81, 0x800, v78
    v_cndmask_b32 v78, v81, v78, vcc
    s_mov_b32 exec_lo, 0
    buffer_store_dword v78, v23, s[36:39], 0 offen
    s_mov_b32 exec_lo, -1
    s_branch L_vctlb
L_pubml:
    ds_read2st64_b64 v[44:47], v80 offset0:96 offset1:97
    ds_read2st64_b64 v[48:51], v80 offset0:98 offset1:99
    v_lshl_add_u32 v17, v76, 2, v77
    s_and_b32 s4, s7, 15
    v_cmp_eq_u32 vcc, s4, v17
    s_waitcnt lgkmcnt(0)
    v_max3_f32 v17, v44, v46, v48
    v_max_f32 v17, v17, v50
    v_mul_f32 v18, s55, v17
    v_fma_f32 v44, v44, s55, -v18
    v_fma_f32 v46, v46, s55, -v18
    v_fma_f32 v48, v48, s55, -v18
    v_fma_f32 v50, v50, s55, -v18
    v_exp_f32 v44, v44
    v_exp_f32 v46, v46
    v_exp_f32 v48, v48
    v_exp_f32 v50, v50
    v_mul_f32 v45, v44, v45
    v_fmac_f32 v45, v46, v47
    v_fmac_f32 v45, v48, v49
    v_fmac_f32 v45, v50, v51
    v_or_b32 v44, s68, v17
    v_and_or_b32 v45, v45, v27, s69
    v_mov_b32 v46, s70
    v_mov_b32 v47, s71
    s_mov_b64 exec, vcc
    s_cmp_lg_u32 s67, 0
    s_cbranch_scc0 L_pubml_slow
    buffer_store_dwordx4 v[44:47], v26, s[36:39], 0 offen
    s_mov_b64 exec, -1
    s_branch L_vent
L_pubml_slow:
    buffer_store_dwordx4 v[44:47], v26, s[36:39], 0 offen sc1
    s_mov_b64 exec, -1
    s_branch L_vent
L_puba:
    ds_read_b128 v[202:205], v169 offset:32768
    ds_read_b128 v[206:209], v169 offset:34816
    ds_read_b128 v[210:213], v169 offset:36864
    ds_read_b128 v[214:217], v169 offset:38912
    s_cmp_lg_u32 s67, 0
    s_waitcnt lgkmcnt(3)
    v_mul_f32 v202, v202, v176
    v_mul_f32 v203, v203, v176
    v_mul_f32 v204, v204, v176
    v_mul_f32 v205, v205, v176
    s_waitcnt lgkmcnt(2)
    v_fmac_f32 v202, v206, v177
    v_fmac_f32 v203, v207, v177
    v_fmac_f32 v204, v208, v177
    v_fmac_f32 v205, v209, v177
    s_waitcnt lgkmcnt(1)
    v_fmac_f32 v202, v210, v178
    v_fmac_f32 v203, v211, v178
    v_fmac_f32 v204, v212, v178
    v_fmac_f32 v205, v213, v178
    s_waitcnt lgkmcnt(0)
    v_fmac_f32 v202, v214, v179
    v_fmac_f32 v203, v215, v179
    v_fmac_f32 v204, v216, v179
    v_fmac_f32 v205, v217, v179
    v_and_or_b32 v196, v202, v27, s68
    v_and_or_b32 v197, v203, v27, s69
    v_and_or_b32 v198, v204, v27, s70
    v_and_or_b32 v199, v205, v27, s71
    s_branch L_vent
L_sta_slow:
    buffer_store_dwordx4 v[196:199], v170, s[36:39], 0 offen sc1
    s_branch L_sta_back
L_lda_slow:
    buffer_load_dwordx4 v[148:151], v171, s[36:39], 0 offen sc1
    buffer_load_dwordx4 v[152:155], v171, s[36:39], 0 offen offset:1024 sc1
    s_branch L_lda_back
L_qslow:
    s_cmp_lg_u32 s3, 0
    s_cbranch_scc1 L_qretry
    buffer_store_dword v14, v15, s[36:39], 0 offen sc1
L_qretry:
    s_sub_u32 s58, s58, 1
    s_cbranch_scc1 L_end
L_pad27:
    s_cbranch_execz L_end
    buffer_load_dwordx4 v[36:39], v79, s[36:39], s56 offen sc1
    buffer_load_dwordx4 v[40:43], v79, s[36:39], s56 offen offset:16 sc1
    buffer_load_dwordx4 v[44:47], v79, s[36:39], s57 offen sc1
    buffer_load_dwordx4 v[48:51], v79, s[36:39], s57 offen offset:16 sc1
    s_waitcnt vmcnt(0)
    v_xor_b32 v78, s96, v36
    v_bitop3_b32 v78, v37, s97, v78 bitop3:0xbe
    v_bitop3_b32 v78, v38, s98, v78 bitop3:0xbe
    v_bitop3_b32 v78, v39, s99, v78 bitop3:0xbe
    v_bitop3_b32 v78, v40, s96, v78 bitop3:0xbe
    v_bitop3_b32 v78, v41, s97, v78 bitop3:0xbe
    v_bitop3_b32 v78, v42, s98, v78 bitop3:0xbe
    v_bitop3_b32 v78, v43, s99, v78 bitop3:0xbe
    v_bitop3_b32 v78, v44, s96, v78 bitop3:0xbe
    v_bitop3_b32 v78, v45, s97, v78 bitop3:0xbe
    v_bitop3_b32 v78, v46, s98, v78 bitop3:0xbe
    v_bitop3_b32 v78, v47, s99, v78 bitop3:0xbe
    v_bitop3_b32 v78, v48, s96, v78 bitop3:0xbe
    v_bitop3_b32 v78, v49, s97, v78 bitop3:0xbe
    v_bitop3_b32 v78, v50, s98, v78 bitop3:0xbe
    v_bitop3_b32 v78, v51, s99, v78 bitop3:0xbe
    v_and_b32 v80, 0x1fff, v78
    v_cmp_ne_u32 vcc, 0, v80
    s_cbranch_vccnz L_qretry
    v_and_b32 v80, 0xe000, v78
L_last:
    v_cmp_ne_u32 vcc, 0, v80
    s_branch L_qok
L_hbar:
    s_mov_b64 exec, -1
    s_waitcnt lgkmcnt(0)
    s_mov_b32 s38, 0x400000
    s_mov_b32 s39, 0x20000
    s_and_b32 s4, s2, 7
    s_lshr_b32 s5, s2, 3
    v_lshlrev_b32 v1, 7, v0
    s_lshr_b32 s6, s5, 4
    s_lshl_b32 s6, s6, 3
    s_add_u32 s6, s6, s4
    s_lshl_b32 s6, s6, 4
    s_and_b32 s7, s5, 15
    s_add_u32 s6, s6, s7
    s_lshl_b32 s6, s6, 7
    s_add_u32 s6, s6, 0x30000
    s_mov_b64 exec, 1
    buffer_load_dword v2, v1, s[36:39], s6 offen
    s_lshr_b32 s6, s5, 4
    s_lshl_b32 s6, s6, 3
    s_add_u32 s6, s6, s4
    s_lshl_b32 s6, s6, 5
    s_and_b32 s7, s5, 15
    s_add_u32 s6, s6, s7
    s_lshl_b32 s6, s6, 7
    s_add_u32 s6, s6, 0x10000
    s_mov_b64 exec, 0x10001
    buffer_load_dword v5, v1, s[36:39], s6 offen
    s_mov_b32 s44, s16
    s_mov_b32 s45, s17
    s_mov_b32 s46, 1024
    s_mov_b32 s47, 0x20000
    s_mov_b64 exec, 0xff
    buffer_load_dword v7, v1, s[44:47], 0 offen
    s_load_dword s8, s[36:37], 0
    s_getreg_b32 s6, hwreg(HW_REG_XCC_ID)
    s_and_b32 s6, s6, 7
    s_lshl_b32 s6, s6, 12
    s_add_u32 s6, s6, 0x40000
    s_mov_b64 exec, 3
    buffer_load_dword v6, v1, s[36:39], s6 offen
    s_barrier
    s_cmp_ge_u32 s2, 8
    s_cbranch_scc1 L_hnoinit
    s_waitcnt vmcnt(0) lgkmcnt(0)
    s_add_u32 s8, s8, 1
    s_lshl_b32 s8, s8, 12
    s_add_u32 s9, s8, 63
    s_mov_b32 exec_lo, -1
    v_cmp_gt_u32 vcc, 4, v0
    v_mov_b32 v8, s9
    v_add_u32 v9, 0x800, v8
    v_lshlrev_b32 v10, 2, v0
    v_cndmask_b32 v8, v9, v8, vcc
    buffer_store_dword v8, v10, s[36:39], s6 offen offset:128
    s_cmp_lg_u32 s2, 0
    s_cbranch_scc1 L_hnoinit
    v_mov_b32 v11, s8
    v_lshlrev_b32 v12, 8, v0
    s_mov_b32 s7, 0x50100
    s_mov_b64 exec, 0x7fff
    buffer_store_dword v11, v12, s[36:39], s7 offen sc1
L_hnoinit:
    s_mov_b64 exec, 0
    s_branch L_pad4
.section .rodata,"a"
.p2align 6
.amdhsa_kernel gated_mix__gqa_block_cached__gqa_block_cached__decode_kernel
  .amdhsa_next_free_vgpr 244
  .amdhsa_next_free_sgpr 102
  .amdhsa_accum_offset 244
  .amdhsa_group_segment_fixed_size 0
  .amdhsa_kernarg_size 112
  .amdhsa_user_sgpr_count 2
  .amdhsa_user_sgpr_kernarg_segment_ptr 1
  .amdhsa_system_sgpr_workgroup_id_x 1
  .amdhsa_float_denorm_mode_32 3
.end_amdhsa_kernel
```
